```python
import torch

def _softmax(x, axis=-1):
    return torch.softmax(x, dim=axis)
def _gelu(x):
    return torch.nn.functional.gelu(x, approximate="tanh")
def _silu(x):
    return torch.nn.functional.silu(x)
def _sigmoid(x):
    return torch.sigmoid(x)
def _layernorm(x, axis=-1, eps=1e-5):
    m = x.mean(dim=axis, keepdim=True)
    v = x.var(dim=axis, keepdim=True, unbiased=False)
    return (x - m) / torch.sqrt(v + eps)
def _scatter_add(tgt, idx, src, axis=0):
    return tgt.clone().index_add_(axis, idx, src)
def _segment_sum(src, seg, n):
    out = torch.zeros((n,) + src.shape[1:], dtype=src.dtype)
    return out.index_add_(0, seg, src)
def _pad(x, pw):
    flat = tuple(v for pair in reversed(pw) for v in pair)
    return torch.nn.functional.pad(x, flat)

kernel_name = 'parallel_sum__ssm_conv_s4d__dense_activation_gelu__prompt'

def setup_inputs():

    _w = (lambda a: (lambda t: t.to(torch.bfloat16) if t.is_floating_point() else t)(torch.as_tensor(a)))
    def _A_setup():
        Bsz, L, D, N = 1, 2048, 512, 128
        return {
            "u": _w((lambda *s: torch.randn(*s, dtype=torch.bfloat16) * 0.05)(Bsz, L, D)),
            "log_A_real": _w((lambda *s: torch.randn(*s, dtype=torch.bfloat16) * 12.8)(D, N) * 0.5),
            "A_imag": _w((lambda *s: torch.randn(*s, dtype=torch.bfloat16) * 0.05)(D, N) * 3.14),
            "C_real": _w((lambda *s: torch.randn(*s, dtype=torch.bfloat16) * 0.1)(D, N) / N ** 0.5),
            "C_imag": _w((lambda *s: torch.randn(*s, dtype=torch.bfloat16) * 0.2)(D, N) / N ** 0.5),
            "log_dt": _w((lambda *s: torch.randn(*s, dtype=torch.bfloat16) * 0.05)(D) * 0.5 - 4.0),
            "D_skip": _w((lambda *s: torch.randn(*s, dtype=torch.bfloat16) * 0.05)(D)),
        }
    _A_in = _A_setup()

    def _B_setup():
        B, S, D, F = 1, 2048, 512, 1792
        return {
            "x": _w((lambda *s: torch.randn(*s, dtype=torch.bfloat16) * 0.05)(B, S, D)),
            "w1": _w((lambda *s: torch.randn(*s, dtype=torch.bfloat16) * 0.8)(D, F) * (D ** -0.5)),
            "b1": _w((lambda *s: torch.randn(*s, dtype=torch.bfloat16) * 12.8)(F) * 0.01),
            "w2": _w((lambda *s: torch.randn(*s, dtype=torch.bfloat16) * 0.8)(F, D) * (F ** -0.5)),
            "b2": _w((lambda *s: torch.randn(*s, dtype=torch.bfloat16) * 12.8)(D) * 0.01),
        }
    _B_in = _B_setup()

    return {
        "A_u": _A_in["u"],
        "A_log_A_real": _A_in["log_A_real"],
        "A_A_imag": _A_in["A_imag"],
        "A_C_real": _A_in["C_real"],
        "A_C_imag": _A_in["C_imag"],
        "A_log_dt": _A_in["log_dt"],
        "A_D_skip": _A_in["D_skip"],
        "B_x": _B_in["x"],
        "B_w1": _B_in["w1"],
        "B_b1": _B_in["b1"],
        "B_w2": _B_in["w2"],
        "B_b2": _B_in["b2"],
    }

def reference(A_u, A_log_A_real, A_A_imag, A_C_real, A_C_imag, A_log_dt, A_D_skip, B_x, B_w1, B_b1, B_w2, B_b2):
    def _A_ref(u, log_A_real, A_imag, C_real, C_imag, log_dt, D_skip):
        L = u.shape[1]
        dt = torch.exp(log_dt)
        A = -torch.exp(log_A_real) + 1j * A_imag
        C = (C_real + 1j * C_imag) * dt[:, None]
        pos = (lambda x, dt: x.to(dt))(torch.arange(L), log_dt.dtype)
        P = torch.exp((A * dt[:, None])[:, :, None] * pos[None, None, :])
        K = 2.0 * torch.einsum("dn,dnl->dl", C, P).real
        L2 = 2 * L
        u_t = (lambda x, *d: x.permute(*d))(u, 0, 2, 1)
        Kf = (lambda x, *a, **k: torch.fft.rfft(x.float(), *a, **k))(K, L2)
        Uf = (lambda x, *a, **k: torch.fft.rfft(x.float(), *a, **k))(u_t, L2)
        y = (lambda x, *a, **k: torch.fft.irfft(x, *a, **k).to(torch.bfloat16))(Uf * Kf[None, :, :], L2)[:, :, :L]
        y = (lambda x, *d: x.permute(*d))(y, 0, 2, 1)
        return y + u * D_skip[None, None, :]

    def _B_ref(x, w1, b1, w2, b2):
        h = torch.einsum("bsd,df->bsf", x, w1) + b1
        h = _gelu(h)
        return torch.einsum("bsf,fd->bsd", h, w2) + b2

    x = A_u
    xn = _layernorm(x, axis=-1)
    return x + _A_ref(xn, A_log_A_real, A_A_imag, A_C_real, A_C_imag, A_log_dt, A_D_skip) + _B_ref(xn, B_w1, B_b1, B_w2, B_b2)
```

```asm
; @launch kernel=mono_kernel grid=(512,1,1) block=(256,1,1) lds=81920
.amdgcn_target "amdgcn-amd-amdhsa--gfx950"
.text
.globl mono_kernel
.p2align 8
.type mono_kernel,@function
mono_kernel:
    s_cmp_ge_u32 s2, 512
    s_cbranch_scc1 M_end
    s_mov_b32 s67, s2
    s_load_dwordx16 s[36:51], s[0:1], 0
    s_load_dwordx8 s[52:59], s[0:1], 64
    s_load_dwordx2 s[60:61], s[0:1], 112
    s_load_dwordx2 s[62:63], s[0:1], 104
    v_lshrrev_b32 v1, 6, v0
    s_mov_b32 s66, 0
    v_readfirstlane_b32 s65, v1
    s_waitcnt lgkmcnt(0)
    s_mov_b32 s8, s60
    s_and_b32 s9, s61, 0xffff
    s_mov_b32 s10, 25165824
    s_mov_b32 s11, 0x00020000
    s_mov_b32 s84, s62
    s_and_b32 s85, s63, 0xffff
    s_mov_b32 s86, 256
    s_mov_b32 s87, 0x00020000
    s_cmp_lt_u32 s2, 256
    s_cbranch_scc1 M_A
    s_sub_u32 s2, s2, 256
    s_setprio 1
    s_lshl_b32 s3, s2, 1
    s_mov_b32 s12, s38
    s_and_b32 s13, s39, 0xffff
    s_mov_b32 s14, 131072
    s_mov_b32 s15, 0x00020000
    s_mov_b32 s16, s40
    s_and_b32 s17, s41, 0xffff
    s_mov_b32 s18, 131072
    s_mov_b32 s19, 0x00020000
    s_mov_b32 s20, s42
    s_and_b32 s21, s43, 0xffff
    s_mov_b32 s22, 131072
    s_mov_b32 s23, 0x00020000
    s_mov_b32 s24, s44
    s_and_b32 s25, s45, 0xffff
    s_mov_b32 s26, 131072
    s_mov_b32 s27, 0x00020000
    s_mov_b32 s28, s46
    s_and_b32 s29, s47, 0xffff
    s_mov_b32 s30, 1024
    s_mov_b32 s31, 0x00020000
    v_and_b32 v1, 127, v0
    s_lshl_b32 s4, s3, 8
    v_lshl_add_u32 v3, v1, 1, s4
    s_lshl_b32 s5, s3, 1
    v_mov_b32 v4, s5
    buffer_load_ushort v200, v3, s[12:15], 0 offen
    buffer_load_ushort v201, v3, s[16:19], 0 offen
    buffer_load_ushort v202, v3, s[20:23], 0 offen
    buffer_load_ushort v203, v3, s[24:27], 0 offen
    buffer_load_ushort v204, v4, s[28:31], 0 offen
    s_add_u32 s3, s3, 1
    s_mov_b32 s12, s38
    s_and_b32 s13, s39, 0xffff
    s_mov_b32 s14, 131072
    s_mov_b32 s15, 0x00020000
    s_mov_b32 s16, s40
    s_and_b32 s17, s41, 0xffff
    s_mov_b32 s18, 131072
    s_mov_b32 s19, 0x00020000
    s_mov_b32 s20, s42
    s_and_b32 s21, s43, 0xffff
    s_mov_b32 s22, 131072
    s_mov_b32 s23, 0x00020000
    s_mov_b32 s24, s44
    s_and_b32 s25, s45, 0xffff
    s_mov_b32 s26, 131072
    s_mov_b32 s27, 0x00020000
    s_mov_b32 s28, s46
    s_and_b32 s29, s47, 0xffff
    s_mov_b32 s30, 1024
    s_mov_b32 s31, 0x00020000
    v_and_b32 v1, 127, v0
    s_lshl_b32 s4, s3, 8
    v_lshl_add_u32 v3, v1, 1, s4
    s_lshl_b32 s5, s3, 1
    v_mov_b32 v4, s5
    buffer_load_ushort v205, v3, s[12:15], 0 offen
    buffer_load_ushort v206, v3, s[16:19], 0 offen
    buffer_load_ushort v207, v3, s[20:23], 0 offen
    buffer_load_ushort v208, v3, s[24:27], 0 offen
    buffer_load_ushort v209, v4, s[28:31], 0 offen
    s_sub_u32 s3, s3, 1
    s_cmp_lg_u32 s2, 0
    s_cbranch_scc1 C_kg0
    v_lshlrev_b32 v4, 7, v0
    v_add_u32 v4, 25100288, v4
    v_mov_b32 v5, 0
    v_cmp_gt_u32 vcc, 64, v0
    s_and_saveexec_b64 s[16:17], vcc
    buffer_store_dword v5, v4, s[8:11], 0 offen sc1
    v_add_u32 v4, 8192, v4
    buffer_store_dword v5, v4, s[8:11], 0 offen sc1
    s_mov_b64 exec, s[16:17]
    s_waitcnt vmcnt(0)
    v_mov_b32 v4, 0
    v_mov_b32 v5, 1
    v_cmp_eq_u32 vcc, 0, v0
    s_and_saveexec_b64 s[16:17], vcc
    buffer_store_dword v5, v4, s[84:87], 0 offen sc1
    s_mov_b64 exec, s[16:17]
    s_mov_b32 s66, 1
C_kg0:
    v_lshlrev_b32 v23, 3, v0
    v_mov_b32 v22, 7
    s_mov_b32 s4, 66560
    v_sub_u32 v24, 2047, v23
    v_cvt_f32_u32 v25, v24
    v_bfe_u32 v26, v25, 16, 1
    v_add_u32 v25, v25, v26
    v_add_u32 v25, 0x7fff, v25
    v_and_b32 v25, 0xffff0000, v25
    v_lshrrev_b32 v26, 23, v25
    v_cvt_u32_f32 v27, v25
    v_subrev_u32 v26, 134, v26
    v_max_i32 v26, 0, v26
    v_min_i32 v26, 3, v26
    v_lshrrev_b32 v28, v26, v27
    v_lshrrev_b32 v29, v26, v22
    v_and_b32 v28, v28, v29
    v_lshl_add_u32 v28, v26, 3, v28
    v_lshrrev_b32 v29, 7, v27
    v_sub_u32 v30, 3, v26
    v_lshlrev_b32 v29, v30, v29
    v_add_u32 v28, v28, v29
    v_bfe_u32 v29, v27, 3, 4
    v_lshl_add_u32 v28, v28, 4, v29
    v_lshl_add_u32 v128, v28, 2, s4
    v_sub_u32 v24, 2046, v23
    v_cvt_f32_u32 v25, v24
    v_bfe_u32 v26, v25, 16, 1
    v_add_u32 v25, v25, v26
    v_add_u32 v25, 0x7fff, v25
    v_and_b32 v25, 0xffff0000, v25
    v_lshrrev_b32 v26, 23, v25
    v_cvt_u32_f32 v27, v25
    v_subrev_u32 v26, 134, v26
    v_max_i32 v26, 0, v26
    v_min_i32 v26, 3, v26
    v_lshrrev_b32 v28, v26, v27
    v_lshrrev_b32 v29, v26, v22
    v_and_b32 v28, v28, v29
    v_lshl_add_u32 v28, v26, 3, v28
    v_lshrrev_b32 v29, 7, v27
    v_sub_u32 v30, 3, v26
    v_lshlrev_b32 v29, v30, v29
    v_add_u32 v28, v28, v29
    v_bfe_u32 v29, v27, 3, 4
    v_lshl_add_u32 v28, v28, 4, v29
    v_lshl_add_u32 v129, v28, 2, s4
    v_sub_u32 v24, 2045, v23
    v_cvt_f32_u32 v25, v24
    v_bfe_u32 v26, v25, 16, 1
    v_add_u32 v25, v25, v26
    v_add_u32 v25, 0x7fff, v25
    v_and_b32 v25, 0xffff0000, v25
    v_lshrrev_b32 v26, 23, v25
    v_cvt_u32_f32 v27, v25
    v_subrev_u32 v26, 134, v26
    v_max_i32 v26, 0, v26
    v_min_i32 v26, 3, v26
    v_lshrrev_b32 v28, v26, v27
    v_lshrrev_b32 v29, v26, v22
    v_and_b32 v28, v28, v29
    v_lshl_add_u32 v28, v26, 3, v28
    v_lshrrev_b32 v29, 7, v27
    v_sub_u32 v30, 3, v26
    v_lshlrev_b32 v29, v30, v29
    v_add_u32 v28, v28, v29
    v_bfe_u32 v29, v27, 3, 4
    v_lshl_add_u32 v28, v28, 4, v29
    v_lshl_add_u32 v130, v28, 2, s4
    v_sub_u32 v24, 2044, v23
    v_cvt_f32_u32 v25, v24
    v_bfe_u32 v26, v25, 16, 1
    v_add_u32 v25, v25, v26
    v_add_u32 v25, 0x7fff, v25
    v_and_b32 v25, 0xffff0000, v25
    v_lshrrev_b32 v26, 23, v25
    v_cvt_u32_f32 v27, v25
    v_subrev_u32 v26, 134, v26
    v_max_i32 v26, 0, v26
    v_min_i32 v26, 3, v26
    v_lshrrev_b32 v28, v26, v27
    v_lshrrev_b32 v29, v26, v22
    v_and_b32 v28, v28, v29
    v_lshl_add_u32 v28, v26, 3, v28
    v_lshrrev_b32 v29, 7, v27
    v_sub_u32 v30, 3, v26
    v_lshlrev_b32 v29, v30, v29
    v_add_u32 v28, v28, v29
    v_bfe_u32 v29, v27, 3, 4
    v_lshl_add_u32 v28, v28, 4, v29
    v_lshl_add_u32 v131, v28, 2, s4
    v_sub_u32 v24, 2043, v23
    v_cvt_f32_u32 v25, v24
    v_bfe_u32 v26, v25, 16, 1
    v_add_u32 v25, v25, v26
    v_add_u32 v25, 0x7fff, v25
    v_and_b32 v25, 0xffff0000, v25
    v_lshrrev_b32 v26, 23, v25
    v_cvt_u32_f32 v27, v25
    v_subrev_u32 v26, 134, v26
    v_max_i32 v26, 0, v26
    v_min_i32 v26, 3, v26
    v_lshrrev_b32 v28, v26, v27
    v_lshrrev_b32 v29, v26, v22
    v_and_b32 v28, v28, v29
    v_lshl_add_u32 v28, v26, 3, v28
    v_lshrrev_b32 v29, 7, v27
    v_sub_u32 v30, 3, v26
    v_lshlrev_b32 v29, v30, v29
    v_add_u32 v28, v28, v29
    v_bfe_u32 v29, v27, 3, 4
    v_lshl_add_u32 v28, v28, 4, v29
    v_lshl_add_u32 v132, v28, 2, s4
    v_sub_u32 v24, 2042, v23
    v_cvt_f32_u32 v25, v24
    v_bfe_u32 v26, v25, 16, 1
    v_add_u32 v25, v25, v26
    v_add_u32 v25, 0x7fff, v25
    v_and_b32 v25, 0xffff0000, v25
    v_lshrrev_b32 v26, 23, v25
    v_cvt_u32_f32 v27, v25
    v_subrev_u32 v26, 134, v26
    v_max_i32 v26, 0, v26
    v_min_i32 v26, 3, v26
    v_lshrrev_b32 v28, v26, v27
    v_lshrrev_b32 v29, v26, v22
    v_and_b32 v28, v28, v29
    v_lshl_add_u32 v28, v26, 3, v28
    v_lshrrev_b32 v29, 7, v27
    v_sub_u32 v30, 3, v26
    v_lshlrev_b32 v29, v30, v29
    v_add_u32 v28, v28, v29
    v_bfe_u32 v29, v27, 3, 4
    v_lshl_add_u32 v28, v28, 4, v29
    v_lshl_add_u32 v133, v28, 2, s4
    v_sub_u32 v24, 2041, v23
    v_cvt_f32_u32 v25, v24
    v_bfe_u32 v26, v25, 16, 1
    v_add_u32 v25, v25, v26
    v_add_u32 v25, 0x7fff, v25
    v_and_b32 v25, 0xffff0000, v25
    v_lshrrev_b32 v26, 23, v25
    v_cvt_u32_f32 v27, v25
    v_subrev_u32 v26, 134, v26
    v_max_i32 v26, 0, v26
    v_min_i32 v26, 3, v26
    v_lshrrev_b32 v28, v26, v27
    v_lshrrev_b32 v29, v26, v22
    v_and_b32 v28, v28, v29
    v_lshl_add_u32 v28, v26, 3, v28
    v_lshrrev_b32 v29, 7, v27
    v_sub_u32 v30, 3, v26
    v_lshlrev_b32 v29, v30, v29
    v_add_u32 v28, v28, v29
    v_bfe_u32 v29, v27, 3, 4
    v_lshl_add_u32 v28, v28, 4, v29
    v_lshl_add_u32 v134, v28, 2, s4
    v_sub_u32 v24, 2040, v23
    v_cvt_f32_u32 v25, v24
    v_bfe_u32 v26, v25, 16, 1
    v_add_u32 v25, v25, v26
    v_add_u32 v25, 0x7fff, v25
    v_and_b32 v25, 0xffff0000, v25
    v_lshrrev_b32 v26, 23, v25
    v_cvt_u32_f32 v27, v25
    v_subrev_u32 v26, 134, v26
    v_max_i32 v26, 0, v26
    v_min_i32 v26, 3, v26
    v_lshrrev_b32 v28, v26, v27
    v_lshrrev_b32 v29, v26, v22
    v_and_b32 v28, v28, v29
    v_lshl_add_u32 v28, v26, 3, v28
    v_lshrrev_b32 v29, 7, v27
    v_sub_u32 v30, 3, v26
    v_lshlrev_b32 v29, v30, v29
    v_add_u32 v28, v28, v29
    v_bfe_u32 v29, v27, 3, 4
    v_lshl_add_u32 v28, v28, 4, v29
    v_lshl_add_u32 v135, v28, 2, s4
C_kg:
    s_mov_b32 s32, 0x3fb8aa3b
    s_mov_b32 s33, 0x32a57060
    s_mov_b32 s34, 0x3f317218
    s_mov_b32 s35, 0x3e22f983
    v_and_b32 v1, 127, v0
    s_waitcnt vmcnt(0)
    v_lshlrev_b32 v5, 16, v200
    v_lshlrev_b32 v6, 16, v201
    v_lshlrev_b32 v7, 16, v202
    v_lshlrev_b32 v8, 16, v203
    v_lshlrev_b32 v9, 16, v204
    v_mul_f32 v11, s32, v9
    v_fma_f32 v12, v9, s32, -v11
    v_fma_f32 v12, v9, s33, v12
    v_exp_f32 v10, v11
    v_mul_f32 v12, s34, v12
    v_fma_f32 v10, v10, v12, v10
    v_cvt_pk_bf16_f32 v10, v10, v10
    v_lshlrev_b32 v10, 16, v10
    v_mul_f32 v11, s32, v5
    v_fma_f32 v12, v5, s32, -v11
    v_fma_f32 v12, v5, s33, v12
    v_exp_f32 v13, v11
    v_mul_f32 v12, s34, v12
    v_fma_f32 v13, v13, v12, v13
    v_cvt_pk_bf16_f32 v13, v13, v13
    v_lshlrev_b32 v13, 16, v13
    v_mul_f32 v13, v13, v10
    v_sub_f32 v13, 0, v13
    v_mul_f32 v14, v6, v10
    v_mul_f32 v15, v7, v10
    v_mul_f32 v16, v8, v10
    v_sub_f32 v20, 0, v14
    v_sub_f32 v21, 0, v16
    v_lshlrev_b32 v17, 3, v1
    s_barrier
    s_cmp_ge_u32 s65, 2
    s_cbranch_scc1 KG1_h1
    v_mul_f32 v30, 0x41000000, v13
    v_mul_f32 v30, s32, v30
    v_exp_f32 v30, v30
    v_mul_f32 v31, 0x41000000, v14
    v_mul_f32 v31, s35, v31
    v_fract_f32 v31, v31
    v_cos_f32 v96, v31
    v_sin_f32 v97, v31
    s_nop 1
    v_mul_f32 v96, v96, v30
    v_mul_f32 v97, v97, v30
    v_mul_f32 v32, 0x3f800000, v13
    v_mul_f32 v32, s32, v32
    v_exp_f32 v32, v32
    v_mul_f32 v33, 0x3f800000, v20
    v_mul_f32 v33, s35, v33
    v_fract_f32 v33, v33
    v_cos_f32 v98, v33
    v_sin_f32 v99, v33
    s_nop 1
    v_mul_f32 v98, v98, v32
    v_mul_f32 v99, v99, v32
    v_mul_f32 v30, 0x43000000, v13
    v_mul_f32 v30, s32, v30
    v_exp_f32 v30, v30
    v_mul_f32 v31, 0x43000000, v20
    v_mul_f32 v31, s35, v31
    v_fract_f32 v31, v31
    v_cos_f32 v100, v31
    v_sin_f32 v101, v31
    s_nop 1
    v_mul_f32 v100, v100, v30
    v_mul_f32 v101, v101, v30
    v_mov_b32 v102, 1.0
    v_mov_b32 v103, 0
    v_mov_b32 v104, v15
    v_mov_b32 v105, v21
    v_pk_mul_f32 v[36:37], v[104:105], v[100:101] op_sel:[1,1] op_sel_hi:[1,0]
    v_pk_fma_f32 v[106:107], v[104:105], v[100:101], v[36:37] op_sel:[0,0,0] op_sel_hi:[0,1,1] neg_lo:[0,0,1]
    ds_write_b64 v17, v[102:103] offset:49920
    ds_write_b64 v17, v[104:105] offset:0
    ds_write_b64 v17, v[106:107] offset:8320
    v_pk_mul_f32 v[36:37], v[102:103], v[96:97] op_sel:[1,1] op_sel_hi:[1,0]
    v_pk_mul_f32 v[38:39], v[104:105], v[98:99] op_sel:[1,1] op_sel_hi:[1,0]
    v_pk_mul_f32 v[40:41], v[106:107], v[98:99] op_sel:[1,1] op_sel_hi:[1,0]
    v_pk_fma_f32 v[102:103], v[102:103], v[96:97], v[36:37] op_sel:[0,0,0] op_sel_hi:[0,1,1] neg_lo:[0,0,1]
    v_pk_fma_f32 v[104:105], v[104:105], v[98:99], v[38:39] op_sel:[0,0,0] op_sel_hi:[0,1,1] neg_lo:[0,0,1]
    v_pk_fma_f32 v[106:107], v[106:107], v[98:99], v[40:41] op_sel:[0,0,0] op_sel_hi:[0,1,1] neg_lo:[0,0,1]
    ds_write_b64 v17, v[102:103] offset:50960
    ds_write_b64 v17, v[104:105] offset:1040
    ds_write_b64 v17, v[106:107] offset:9360
    v_pk_mul_f32 v[36:37], v[102:103], v[96:97] op_sel:[1,1] op_sel_hi:[1,0]
    v_pk_mul_f32 v[38:39], v[104:105], v[98:99] op_sel:[1,1] op_sel_hi:[1,0]
    v_pk_mul_f32 v[40:41], v[106:107], v[98:99] op_sel:[1,1] op_sel_hi:[1,0]
    v_pk_fma_f32 v[102:103], v[102:103], v[96:97], v[36:37] op_sel:[0,0,0] op_sel_hi:[0,1,1] neg_lo:[0,0,1]
    v_pk_fma_f32 v[104:105], v[104:105], v[98:99], v[38:39] op_sel:[0,0,0] op_sel_hi:[0,1,1] neg_lo:[0,0,1]
    v_pk_fma_f32 v[106:107], v[106:107], v[98:99], v[40:41] op_sel:[0,0,0] op_sel_hi:[0,1,1] neg_lo:[0,0,1]
    ds_write_b64 v17, v[102:103] offset:52000
    ds_write_b64 v17, v[104:105] offset:2080
    ds_write_b64 v17, v[106:107] offset:10400
    v_pk_mul_f32 v[36:37], v[102:103], v[96:97] op_sel:[1,1] op_sel_hi:[1,0]
    v_pk_mul_f32 v[38:39], v[104:105], v[98:99] op_sel:[1,1] op_sel_hi:[1,0]
    v_pk_mul_f32 v[40:41], v[106:107], v[98:99] op_sel:[1,1] op_sel_hi:[1,0]
    v_pk_fma_f32 v[102:103], v[102:103], v[96:97], v[36:37] op_sel:[0,0,0] op_sel_hi:[0,1,1] neg_lo:[0,0,1]
    v_pk_fma_f32 v[104:105], v[104:105], v[98:99], v[38:39] op_sel:[0,0,0] op_sel_hi:[0,1,1] neg_lo:[0,0,1]
    v_pk_fma_f32 v[106:107], v[106:107], v[98:99], v[40:41] op_sel:[0,0,0] op_sel_hi:[0,1,1] neg_lo:[0,0,1]
    ds_write_b64 v17, v[102:103] offset:53040
    ds_write_b64 v17, v[104:105] offset:3120
    ds_write_b64 v17, v[106:107] offset:11440
    v_pk_mul_f32 v[36:37], v[102:103], v[96:97] op_sel:[1,1] op_sel_hi:[1,0]
    v_pk_mul_f32 v[38:39], v[104:105], v[98:99] op_sel:[1,1] op_sel_hi:[1,0]
    v_pk_mul_f32 v[40:41], v[106:107], v[98:99] op_sel:[1,1] op_sel_hi:[1,0]
    v_pk_fma_f32 v[102:103], v[102:103], v[96:97], v[36:37] op_sel:[0,0,0] op_sel_hi:[0,1,1] neg_lo:[0,0,1]
    v_pk_fma_f32 v[104:105], v[104:105], v[98:99], v[38:39] op_sel:[0,0,0] op_sel_hi:[0,1,1] neg_lo:[0,0,1]
    v_pk_fma_f32 v[106:107], v[106:107], v[98:99], v[40:41] op_sel:[0,0,0] op_sel_hi:[0,1,1] neg_lo:[0,0,1]
    ds_write_b64 v17, v[102:103] offset:54080
    ds_write_b64 v17, v[104:105] offset:4160
    ds_write_b64 v17, v[106:107] offset:12480
    v_pk_mul_f32 v[36:37], v[102:103], v[96:97] op_sel:[1,1] op_sel_hi:[1,0]
    v_pk_mul_f32 v[38:39], v[104:105], v[98:99] op_sel:[1,1] op_sel_hi:[1,0]
    v_pk_mul_f32 v[40:41], v[106:107], v[98:99] op_sel:[1,1] op_sel_hi:[1,0]
    v_pk_fma_f32 v[102:103], v[102:103], v[96:97], v[36:37] op_sel:[0,0,0] op_sel_hi:[0,1,1] neg_lo:[0,0,1]
    v_pk_fma_f32 v[104:105], v[104:105], v[98:99], v[38:39] op_sel:[0,0,0] op_sel_hi:[0,1,1] neg_lo:[0,0,1]
    v_pk_fma_f32 v[106:107], v[106:107], v[98:99], v[40:41] op_sel:[0,0,0] op_sel_hi:[0,1,1] neg_lo:[0,0,1]
    ds_write_b64 v17, v[102:103] offset:55120
    ds_write_b64 v17, v[104:105] offset:5200
    ds_write_b64 v17, v[106:107] offset:13520
    v_pk_mul_f32 v[36:37], v[102:103], v[96:97] op_sel:[1,1] op_sel_hi:[1,0]
    v_pk_mul_f32 v[38:39], v[104:105], v[98:99] op_sel:[1,1] op_sel_hi:[1,0]
    v_pk_mul_f32 v[40:41], v[106:107], v[98:99] op_sel:[1,1] op_sel_hi:[1,0]
    v_pk_fma_f32 v[102:103], v[102:103], v[96:97], v[36:37] op_sel:[0,0,0] op_sel_hi:[0,1,1] neg_lo:[0,0,1]
    v_pk_fma_f32 v[104:105], v[104:105], v[98:99], v[38:39] op_sel:[0,0,0] op_sel_hi:[0,1,1] neg_lo:[0,0,1]
    v_pk_fma_f32 v[106:107], v[106:107], v[98:99], v[40:41] op_sel:[0,0,0] op_sel_hi:[0,1,1] neg_lo:[0,0,1]
    ds_write_b64 v17, v[102:103] offset:56160
    ds_write_b64 v17, v[104:105] offset:6240
    ds_write_b64 v17, v[106:107] offset:14560
    v_pk_mul_f32 v[36:37], v[102:103], v[96:97] op_sel:[1,1] op_sel_hi:[1,0]
    v_pk_mul_f32 v[38:39], v[104:105], v[98:99] op_sel:[1,1] op_sel_hi:[1,0]
    v_pk_mul_f32 v[40:41], v[106:107], v[98:99] op_sel:[1,1] op_sel_hi:[1,0]
    v_pk_fma_f32 v[102:103], v[102:103], v[96:97], v[36:37] op_sel:[0,0,0] op_sel_hi:[0,1,1] neg_lo:[0,0,1]
    v_pk_fma_f32 v[104:105], v[104:105], v[98:99], v[38:39] op_sel:[0,0,0] op_sel_hi:[0,1,1] neg_lo:[0,0,1]
    v_pk_fma_f32 v[106:107], v[106:107], v[98:99], v[40:41] op_sel:[0,0,0] op_sel_hi:[0,1,1] neg_lo:[0,0,1]
    ds_write_b64 v17, v[102:103] offset:57200
    ds_write_b64 v17, v[104:105] offset:7280
    ds_write_b64 v17, v[106:107] offset:15600
    v_pk_mul_f32 v[36:37], v[102:103], v[96:97] op_sel:[1,1] op_sel_hi:[1,0]
    v_pk_fma_f32 v[102:103], v[102:103], v[96:97], v[36:37] op_sel:[0,0,0] op_sel_hi:[0,1,1] neg_lo:[0,0,1]
    ds_write_b64 v17, v[102:103] offset:58240
    v_pk_mul_f32 v[36:37], v[102:103], v[96:97] op_sel:[1,1] op_sel_hi:[1,0]
    v_pk_fma_f32 v[102:103], v[102:103], v[96:97], v[36:37] op_sel:[0,0,0] op_sel_hi:[0,1,1] neg_lo:[0,0,1]
    ds_write_b64 v17, v[102:103] offset:59280
    v_pk_mul_f32 v[36:37], v[102:103], v[96:97] op_sel:[1,1] op_sel_hi:[1,0]
    v_pk_fma_f32 v[102:103], v[102:103], v[96:97], v[36:37] op_sel:[0,0,0] op_sel_hi:[0,1,1] neg_lo:[0,0,1]
    ds_write_b64 v17, v[102:103] offset:60320
    v_pk_mul_f32 v[36:37], v[102:103], v[96:97] op_sel:[1,1] op_sel_hi:[1,0]
    v_pk_fma_f32 v[102:103], v[102:103], v[96:97], v[36:37] op_sel:[0,0,0] op_sel_hi:[0,1,1] neg_lo:[0,0,1]
    ds_write_b64 v17, v[102:103] offset:61360
    v_pk_mul_f32 v[36:37], v[102:103], v[96:97] op_sel:[1,1] op_sel_hi:[1,0]
    v_pk_fma_f32 v[102:103], v[102:103], v[96:97], v[36:37] op_sel:[0,0,0] op_sel_hi:[0,1,1] neg_lo:[0,0,1]
    ds_write_b64 v17, v[102:103] offset:62400
    v_pk_mul_f32 v[36:37], v[102:103], v[96:97] op_sel:[1,1] op_sel_hi:[1,0]
    v_pk_fma_f32 v[102:103], v[102:103], v[96:97], v[36:37] op_sel:[0,0,0] op_sel_hi:[0,1,1] neg_lo:[0,0,1]
    ds_write_b64 v17, v[102:103] offset:63440
    v_pk_mul_f32 v[36:37], v[102:103], v[96:97] op_sel:[1,1] op_sel_hi:[1,0]
    v_pk_fma_f32 v[102:103], v[102:103], v[96:97], v[36:37] op_sel:[0,0,0] op_sel_hi:[0,1,1] neg_lo:[0,0,1]
    ds_write_b64 v17, v[102:103] offset:64480
    v_pk_mul_f32 v[36:37], v[102:103], v[96:97] op_sel:[1,1] op_sel_hi:[1,0]
    v_pk_fma_f32 v[102:103], v[102:103], v[96:97], v[36:37] op_sel:[0,0,0] op_sel_hi:[0,1,1] neg_lo:[0,0,1]
    ds_write_b64 v17, v[102:103] offset:65520
    s_branch KG1_j
KG1_h1:
    v_mul_f32 v30, 0x43000000, v13
    v_mul_f32 v30, s32, v30
    v_exp_f32 v30, v30
    v_mul_f32 v31, 0x43000000, v20
    v_mul_f32 v31, s35, v31
    v_fract_f32 v31, v31
    v_cos_f32 v96, v31
    v_sin_f32 v97, v31
    s_nop 1
    v_mul_f32 v96, v96, v30
    v_mul_f32 v97, v97, v30
    v_mul_f32 v32, 0x40000000, v13
    v_mul_f32 v32, s32, v32
    v_exp_f32 v32, v32
    v_mul_f32 v33, 0x40000000, v20
    v_mul_f32 v33, s35, v33
    v_fract_f32 v33, v33
    v_cos_f32 v98, v33
    v_sin_f32 v99, v33
    s_nop 1
    v_mul_f32 v98, v98, v32
    v_mul_f32 v99, v99, v32
    v_mul_f32 v30, 0x40800000, v13
    v_mul_f32 v30, s32, v30
    v_exp_f32 v30, v30
    v_mul_f32 v31, 0x40800000, v20
    v_mul_f32 v31, s35, v31
    v_fract_f32 v31, v31
    v_cos_f32 v100, v31
    v_sin_f32 v101, v31
    s_nop 1
    v_mul_f32 v100, v100, v30
    v_mul_f32 v101, v101, v30
    v_mov_b32 v102, v15
    v_mov_b32 v103, v21
    v_pk_mul_f32 v[36:37], v[102:103], v[96:97] op_sel:[1,1] op_sel_hi:[1,0]
    v_pk_fma_f32 v[102:103], v[102:103], v[96:97], v[36:37] op_sel:[0,0,0] op_sel_hi:[0,1,1] neg_lo:[0,0,1]
    v_pk_mul_f32 v[36:37], v[102:103], v[96:97] op_sel:[1,1] op_sel_hi:[1,0]
    v_pk_fma_f32 v[104:105], v[102:103], v[96:97], v[36:37] op_sel:[0,0,0] op_sel_hi:[0,1,1] neg_lo:[0,0,1]
    v_pk_mul_f32 v[36:37], v[104:105], v[96:97] op_sel:[1,1] op_sel_hi:[1,0]
    v_pk_fma_f32 v[106:107], v[104:105], v[96:97], v[36:37] op_sel:[0,0,0] op_sel_hi:[0,1,1] neg_lo:[0,0,1]
    v_pk_mul_f32 v[36:37], v[106:107], v[96:97] op_sel:[1,1] op_sel_hi:[1,0]
    v_pk_fma_f32 v[108:109], v[106:107], v[96:97], v[36:37] op_sel:[0,0,0] op_sel_hi:[0,1,1] neg_lo:[0,0,1]
    v_pk_mul_f32 v[36:37], v[108:109], v[96:97] op_sel:[1,1] op_sel_hi:[1,0]
    v_pk_fma_f32 v[110:111], v[108:109], v[96:97], v[36:37] op_sel:[0,0,0] op_sel_hi:[0,1,1] neg_lo:[0,0,1]
    v_pk_mul_f32 v[36:37], v[110:111], v[96:97] op_sel:[1,1] op_sel_hi:[1,0]
    v_pk_fma_f32 v[112:113], v[110:111], v[96:97], v[36:37] op_sel:[0,0,0] op_sel_hi:[0,1,1] neg_lo:[0,0,1]
    v_pk_mul_f32 v[36:37], v[112:113], v[96:97] op_sel:[1,1] op_sel_hi:[1,0]
    v_pk_fma_f32 v[114:115], v[112:113], v[96:97], v[36:37] op_sel:[0,0,0] op_sel_hi:[0,1,1] neg_lo:[0,0,1]
    v_pk_mul_f32 v[36:37], v[114:115], v[96:97] op_sel:[1,1] op_sel_hi:[1,0]
    v_pk_fma_f32 v[102:103], v[114:115], v[96:97], v[36:37] op_sel:[0,0,0] op_sel_hi:[0,1,1] neg_lo:[0,0,1]
    ds_write_b64 v17, v[102:103] offset:33280
    v_pk_mul_f32 v[36:37], v[102:103], v[96:97] op_sel:[1,1] op_sel_hi:[1,0]
    v_pk_fma_f32 v[102:103], v[102:103], v[96:97], v[36:37] op_sel:[0,0,0] op_sel_hi:[0,1,1] neg_lo:[0,0,1]
    ds_write_b64 v17, v[102:103] offset:34320
    v_pk_mul_f32 v[36:37], v[102:103], v[96:97] op_sel:[1,1] op_sel_hi:[1,0]
    v_pk_fma_f32 v[102:103], v[102:103], v[96:97], v[36:37] op_sel:[0,0,0] op_sel_hi:[0,1,1] neg_lo:[0,0,1]
    ds_write_b64 v17, v[102:103] offset:35360
    v_pk_mul_f32 v[36:37], v[102:103], v[96:97] op_sel:[1,1] op_sel_hi:[1,0]
    v_pk_fma_f32 v[102:103], v[102:103], v[96:97], v[36:37] op_sel:[0,0,0] op_sel_hi:[0,1,1] neg_lo:[0,0,1]
    ds_write_b64 v17, v[102:103] offset:36400
    v_pk_mul_f32 v[36:37], v[102:103], v[96:97] op_sel:[1,1] op_sel_hi:[1,0]
    v_pk_fma_f32 v[102:103], v[102:103], v[96:97], v[36:37] op_sel:[0,0,0] op_sel_hi:[0,1,1] neg_lo:[0,0,1]
    ds_write_b64 v17, v[102:103] offset:37440
    v_pk_mul_f32 v[36:37], v[102:103], v[96:97] op_sel:[1,1] op_sel_hi:[1,0]
    v_pk_fma_f32 v[102:103], v[102:103], v[96:97], v[36:37] op_sel:[0,0,0] op_sel_hi:[0,1,1] neg_lo:[0,0,1]
    ds_write_b64 v17, v[102:103] offset:38480
    v_pk_mul_f32 v[36:37], v[102:103], v[96:97] op_sel:[1,1] op_sel_hi:[1,0]
    v_pk_fma_f32 v[102:103], v[102:103], v[96:97], v[36:37] op_sel:[0,0,0] op_sel_hi:[0,1,1] neg_lo:[0,0,1]
    ds_write_b64 v17, v[102:103] offset:39520
    v_pk_mul_f32 v[36:37], v[102:103], v[96:97] op_sel:[1,1] op_sel_hi:[1,0]
    v_pk_fma_f32 v[102:103], v[102:103], v[96:97], v[36:37] op_sel:[0,0,0] op_sel_hi:[0,1,1] neg_lo:[0,0,1]
    ds_write_b64 v17, v[102:103] offset:40560
    v_pk_mul_f32 v[36:37], v[102:103], v[96:97] op_sel:[1,1] op_sel_hi:[1,0]
    v_pk_fma_f32 v[102:103], v[102:103], v[96:97], v[36:37] op_sel:[0,0,0] op_sel_hi:[0,1,1] neg_lo:[0,0,1]
    ds_write_b64 v17, v[102:103] offset:41600
    ds_write_b64 v17, v[108:109] offset:24960
    ds_write_b64 v17, v[110:111] offset:27040
    ds_write_b64 v17, v[112:113] offset:29120
    ds_write_b64 v17, v[114:115] offset:31200
    v_pk_mul_f32 v[116:117], v[108:109], v[100:101] op_sel:[1,1] op_sel_hi:[1,0]
    v_pk_mul_f32 v[118:119], v[110:111], v[100:101] op_sel:[1,1] op_sel_hi:[1,0]
    v_pk_mul_f32 v[120:121], v[112:113], v[100:101] op_sel:[1,1] op_sel_hi:[1,0]
    v_pk_mul_f32 v[122:123], v[114:115], v[100:101] op_sel:[1,1] op_sel_hi:[1,0]
    v_pk_fma_f32 v[108:109], v[108:109], v[100:101], v[116:117] op_sel:[0,0,0] op_sel_hi:[0,1,1] neg_lo:[0,0,1]
    v_pk_fma_f32 v[110:111], v[110:111], v[100:101], v[118:119] op_sel:[0,0,0] op_sel_hi:[0,1,1] neg_lo:[0,0,1]
    v_pk_fma_f32 v[112:113], v[112:113], v[100:101], v[120:121] op_sel:[0,0,0] op_sel_hi:[0,1,1] neg_lo:[0,0,1]
    v_pk_fma_f32 v[114:115], v[114:115], v[100:101], v[122:123] op_sel:[0,0,0] op_sel_hi:[0,1,1] neg_lo:[0,0,1]
    ds_write_b64 v17, v[108:109] offset:26000
    ds_write_b64 v17, v[110:111] offset:28080
    ds_write_b64 v17, v[112:113] offset:30160
    ds_write_b64 v17, v[114:115] offset:32240
    ds_write_b64 v17, v[104:105] offset:16640
    ds_write_b64 v17, v[106:107] offset:20800
    v_pk_mul_f32 v[36:37], v[104:105], v[98:99] op_sel:[1,1] op_sel_hi:[1,0]
    v_pk_mul_f32 v[38:39], v[106:107], v[98:99] op_sel:[1,1] op_sel_hi:[1,0]
    v_pk_fma_f32 v[104:105], v[104:105], v[98:99], v[36:37] op_sel:[0,0,0] op_sel_hi:[0,1,1] neg_lo:[0,0,1]
    v_pk_fma_f32 v[106:107], v[106:107], v[98:99], v[38:39] op_sel:[0,0,0] op_sel_hi:[0,1,1] neg_lo:[0,0,1]
    ds_write_b64 v17, v[104:105] offset:17680
    ds_write_b64 v17, v[106:107] offset:21840
    v_pk_mul_f32 v[36:37], v[104:105], v[98:99] op_sel:[1,1] op_sel_hi:[1,0]
    v_pk_mul_f32 v[38:39], v[106:107], v[98:99] op_sel:[1,1] op_sel_hi:[1,0]
    v_pk_fma_f32 v[104:105], v[104:105], v[98:99], v[36:37] op_sel:[0,0,0] op_sel_hi:[0,1,1] neg_lo:[0,0,1]
    v_pk_fma_f32 v[106:107], v[106:107], v[98:99], v[38:39] op_sel:[0,0,0] op_sel_hi:[0,1,1] neg_lo:[0,0,1]
    ds_write_b64 v17, v[104:105] offset:18720
    ds_write_b64 v17, v[106:107] offset:22880
    v_pk_mul_f32 v[36:37], v[104:105], v[98:99] op_sel:[1,1] op_sel_hi:[1,0]
    v_pk_mul_f32 v[38:39], v[106:107], v[98:99] op_sel:[1,1] op_sel_hi:[1,0]
    v_pk_fma_f32 v[104:105], v[104:105], v[98:99], v[36:37] op_sel:[0,0,0] op_sel_hi:[0,1,1] neg_lo:[0,0,1]
    v_pk_fma_f32 v[106:107], v[106:107], v[98:99], v[38:39] op_sel:[0,0,0] op_sel_hi:[0,1,1] neg_lo:[0,0,1]
    ds_write_b64 v17, v[104:105] offset:19760
    ds_write_b64 v17, v[106:107] offset:23920
KG1_j:
    v_lshrrev_b32 v40, 6, v0
    v_and_b32 v41, 63, v0
    v_and_b32 v45, 15, v41
    v_mul_u32_u24 v44, 1040, v45
    v_lshrrev_b32 v45, 4, v41
    v_lshl_add_u32 v44, v45, 4, v44
    v_lshl_add_u32 v44, v40, 8, v44
    v_lshlrev_b32 v46, 8, v45
    v_and_b32 v47, 15, v41
    v_lshl_add_u32 v46, v47, 2, v46
    v_mul_u32_u24 v47, 3072, v40
    v_add_u32 v46, v46, v47
    v_add_u32 v46, 66560, v46
    v_mov_b32 v48, 0
    v_mov_b32 v49, 0
    v_mov_b32 v50, 0
    v_mov_b32 v51, 0
    v_mov_b32 v52, 0
    v_mov_b32 v53, 0
    v_mov_b32 v54, 0
    v_mov_b32 v55, 0
    v_mov_b32 v56, 0
    v_mov_b32 v57, 0
    v_mov_b32 v58, 0
    v_mov_b32 v59, 0
    s_waitcnt lgkmcnt(0)
    s_bitcmp1_b32 s3, 0
    s_cbranch_scc0 KG1_np
    s_cmp_lg_u32 s65, 0
    s_cbranch_scc1 KG1_np
    s_cmp_lg_u32 s66, 0
    s_cbranch_scc1 C_ic_done
    v_mov_b32 v4, 0
    s_mov_b32 s46, 0
C_ic:
    buffer_load_dword v5, v4, s[84:87], 0 offen sc1
    s_waitcnt vmcnt(0)
    v_readfirstlane_b32 s45, v5
    s_cmp_lg_u32 s45, 0
    s_cbranch_scc1 C_ic_ok
    s_add_u32 s46, s46, 1
    s_cmp_ge_u32 s46, 0x20000
    s_cbranch_scc1 C_ic_ok
    s_sleep 2
    s_branch C_ic
C_ic_ok:
    s_mov_b32 s66, 1
C_ic_done:
    v_and_b32 v4, 15, v0
    v_lshlrev_b32 v4, 7, v4
    v_add_u32 v4, 25103360, v4
    v_mov_b32 v6, 16
    s_mov_b32 s46, 0
C_pl:
    buffer_load_dword v5, v4, s[8:11], 0 offen sc1
    s_waitcnt vmcnt(0)
    v_cmp_lt_u32 vcc, v5, v6
    s_cbranch_vccz C_pl_ok
    s_add_u32 s46, s46, 1
    s_cmp_ge_u32 s46, 0x20000
    s_cbranch_scc1 C_pl_ok
    s_sleep 2
    s_branch C_pl
C_pl_ok:
KG1_np:
    s_barrier
    s_bitcmp1_b32 s3, 0
    s_cbranch_scc0 KG1_ng
    s_lshr_b32 s20, s3, 4
    s_lshl_b32 s20, s20, 10
    s_bfe_u32 s21, s3, 0x10003
    s_lshl_b32 s21, s21, 9
    s_add_u32 s20, s20, s21
    s_and_b32 s21, s3, 6
    s_lshl_b32 s21, s21, 1
    s_add_u32 s20, s20, s21
    s_add_u32 s20, s20, 0
    v_lshrrev_b32 v5, 2, v0
    v_lshlrev_b32 v5, 15, v5
    v_and_b32 v6, 3, v0
    v_lshl_add_u32 v5, v6, 7, v5
    buffer_load_dword v160, v5, s[8:11], s20 offen offset:0
    buffer_load_dword v161, v5, s[8:11], s20 offen offset:16
    buffer_load_dword v162, v5, s[8:11], s20 offen offset:32
    buffer_load_dword v163, v5, s[8:11], s20 offen offset:48
    buffer_load_dword v164, v5, s[8:11], s20 offen offset:64
    buffer_load_dword v165, v5, s[8:11], s20 offen offset:80
    buffer_load_dword v166, v5, s[8:11], s20 offen offset:96
    buffer_load_dword v167, v5, s[8:11], s20 offen offset:112
KG1_ng:
    ds_read_b128 v[64:67], v44 offset:49920
    ds_read_b128 v[80:83], v44 offset:0
    ds_read_b128 v[96:99], v44 offset:16640
    ds_read_b128 v[112:115], v44 offset:33280
    ds_read_b128 v[68:71], v44 offset:49984
    ds_read_b128 v[84:87], v44 offset:64
    ds_read_b128 v[100:103], v44 offset:16704
    ds_read_b128 v[116:119], v44 offset:33344
    ds_read_b128 v[72:75], v44 offset:50048
    ds_read_b128 v[88:91], v44 offset:128
    ds_read_b128 v[104:107], v44 offset:16768
    ds_read_b128 v[120:123], v44 offset:33408
    ds_read_b128 v[76:79], v44 offset:50112
    ds_read_b128 v[92:95], v44 offset:192
    ds_read_b128 v[108:111], v44 offset:16832
    ds_read_b128 v[124:127], v44 offset:33472
    s_waitcnt lgkmcnt(12)
    v_mfma_f32_16x16x4_f32 v[48:51], v80, v64, v[48:51]
    v_mfma_f32_16x16x4_f32 v[52:55], v96, v64, v[52:55]
    v_mfma_f32_16x16x4_f32 v[56:59], v112, v64, v[56:59]
    v_mfma_f32_16x16x4_f32 v[48:51], v81, v65, v[48:51]
    v_mfma_f32_16x16x4_f32 v[52:55], v97, v65, v[52:55]
    v_mfma_f32_16x16x4_f32 v[56:59], v113, v65, v[56:59]
    v_mfma_f32_16x16x4_f32 v[48:51], v82, v66, v[48:51]
    v_mfma_f32_16x16x4_f32 v[52:55], v98, v66, v[52:55]
    v_mfma_f32_16x16x4_f32 v[56:59], v114, v66, v[56:59]
    v_mfma_f32_16x16x4_f32 v[48:51], v83, v67, v[48:51]
    v_mfma_f32_16x16x4_f32 v[52:55], v99, v67, v[52:55]
    v_mfma_f32_16x16x4_f32 v[56:59], v115, v67, v[56:59]
    s_waitcnt lgkmcnt(8)
    v_mfma_f32_16x16x4_f32 v[48:51], v84, v68, v[48:51]
    v_mfma_f32_16x16x4_f32 v[52:55], v100, v68, v[52:55]
    v_mfma_f32_16x16x4_f32 v[56:59], v116, v68, v[56:59]
    v_mfma_f32_16x16x4_f32 v[48:51], v85, v69, v[48:51]
    v_mfma_f32_16x16x4_f32 v[52:55], v101, v69, v[52:55]
    v_mfma_f32_16x16x4_f32 v[56:59], v117, v69, v[56:59]
    v_mfma_f32_16x16x4_f32 v[48:51], v86, v70, v[48:51]
    v_mfma_f32_16x16x4_f32 v[52:55], v102, v70, v[52:55]
    v_mfma_f32_16x16x4_f32 v[56:59], v118, v70, v[56:59]
    v_mfma_f32_16x16x4_f32 v[48:51], v87, v71, v[48:51]
    v_mfma_f32_16x16x4_f32 v[52:55], v103, v71, v[52:55]
    v_mfma_f32_16x16x4_f32 v[56:59], v119, v71, v[56:59]
    s_waitcnt lgkmcnt(4)
    v_mfma_f32_16x16x4_f32 v[48:51], v88, v72, v[48:51]
    v_mfma_f32_16x16x4_f32 v[52:55], v104, v72, v[52:55]
    v_mfma_f32_16x16x4_f32 v[56:59], v120, v72, v[56:59]
    v_mfma_f32_16x16x4_f32 v[48:51], v89, v73, v[48:51]
    v_mfma_f32_16x16x4_f32 v[52:55], v105, v73, v[52:55]
    v_mfma_f32_16x16x4_f32 v[56:59], v121, v73, v[56:59]
    v_mfma_f32_16x16x4_f32 v[48:51], v90, v74, v[48:51]
    v_mfma_f32_16x16x4_f32 v[52:55], v106, v74, v[52:55]
    v_mfma_f32_16x16x4_f32 v[56:59], v122, v74, v[56:59]
    v_mfma_f32_16x16x4_f32 v[48:51], v91, v75, v[48:51]
    v_mfma_f32_16x16x4_f32 v[52:55], v107, v75, v[52:55]
    v_mfma_f32_16x16x4_f32 v[56:59], v123, v75, v[56:59]
    s_waitcnt lgkmcnt(0)
    v_mfma_f32_16x16x4_f32 v[48:51], v92, v76, v[48:51]
    v_mfma_f32_16x16x4_f32 v[52:55], v108, v76, v[52:55]
    v_mfma_f32_16x16x4_f32 v[56:59], v124, v76, v[56:59]
    v_mfma_f32_16x16x4_f32 v[48:51], v93, v77, v[48:51]
    v_mfma_f32_16x16x4_f32 v[52:55], v109, v77, v[52:55]
    v_mfma_f32_16x16x4_f32 v[56:59], v125, v77, v[56:59]
    v_mfma_f32_16x16x4_f32 v[48:51], v94, v78, v[48:51]
    v_mfma_f32_16x16x4_f32 v[52:55], v110, v78, v[52:55]
    v_mfma_f32_16x16x4_f32 v[56:59], v126, v78, v[56:59]
    v_mfma_f32_16x16x4_f32 v[48:51], v95, v79, v[48:51]
    v_mfma_f32_16x16x4_f32 v[52:55], v111, v79, v[52:55]
    v_mfma_f32_16x16x4_f32 v[56:59], v127, v79, v[56:59]
    s_nop 15
    ds_write_b32 v46, v48 offset:0
    ds_write_b32 v46, v49 offset:64
    ds_write_b32 v46, v50 offset:128
    ds_write_b32 v46, v51 offset:192
    ds_write_b32 v46, v52 offset:1024
    ds_write_b32 v46, v53 offset:1088
    ds_write_b32 v46, v54 offset:1152
    ds_write_b32 v46, v55 offset:1216
    ds_write_b32 v46, v56 offset:2048
    ds_write_b32 v46, v57 offset:2112
    ds_write_b32 v46, v58 offset:2176
    ds_write_b32 v46, v59 offset:2240
    s_waitcnt lgkmcnt(0)
    s_barrier
    ds_read_b32 v64, v128 offset:0
    ds_read_b32 v74, v128 offset:3072
    ds_read_b32 v84, v128 offset:6144
    ds_read_b32 v94, v128 offset:9216
    ds_read_b32 v65, v129 offset:0
    ds_read_b32 v75, v129 offset:3072
    ds_read_b32 v85, v129 offset:6144
    ds_read_b32 v95, v129 offset:9216
    ds_read_b32 v66, v130 offset:0
    ds_read_b32 v76, v130 offset:3072
    ds_read_b32 v86, v130 offset:6144
    ds_read_b32 v96, v130 offset:9216
    ds_read_b32 v67, v131 offset:0
    ds_read_b32 v77, v131 offset:3072
    ds_read_b32 v87, v131 offset:6144
    ds_read_b32 v97, v131 offset:9216
    ds_read_b32 v68, v132 offset:0
    ds_read_b32 v78, v132 offset:3072
    ds_read_b32 v88, v132 offset:6144
    ds_read_b32 v98, v132 offset:9216
    ds_read_b32 v69, v133 offset:0
    ds_read_b32 v79, v133 offset:3072
    ds_read_b32 v89, v133 offset:6144
    ds_read_b32 v99, v133 offset:9216
    ds_read_b32 v70, v134 offset:0
    ds_read_b32 v80, v134 offset:3072
    ds_read_b32 v90, v134 offset:6144
    ds_read_b32 v100, v134 offset:9216
    ds_read_b32 v71, v135 offset:0
    ds_read_b32 v81, v135 offset:3072
    ds_read_b32 v91, v135 offset:6144
    ds_read_b32 v101, v135 offset:9216
    v_lshlrev_b32 v23, 4, v0
    s_waitcnt lgkmcnt(0)
    v_add_f32 v64, v64, v74
    v_add_f32 v84, v84, v94
    v_add_f32 v110, v64, v84
    v_add_f32 v65, v65, v75
    v_add_f32 v85, v85, v95
    v_add_f32 v111, v65, v85
    v_add_f32 v66, v66, v76
    v_add_f32 v86, v86, v96
    v_add_f32 v112, v66, v86
    v_add_f32 v67, v67, v77
    v_add_f32 v87, v87, v97
    v_add_f32 v113, v67, v87
    v_add_f32 v68, v68, v78
    v_add_f32 v88, v88, v98
    v_add_f32 v114, v68, v88
    v_add_f32 v69, v69, v79
    v_add_f32 v89, v89, v99
    v_add_f32 v115, v69, v89
    v_add_f32 v70, v70, v80
    v_add_f32 v90, v90, v100
    v_add_f32 v116, v70, v90
    v_add_f32 v71, v71, v81
    v_add_f32 v91, v91, v101
    v_add_f32 v117, v71, v91
    v_add_f32 v70, v110, v110
    v_add_f32 v71, v111, v111
    v_add_f32 v72, v112, v112
    v_add_f32 v73, v113, v113
    v_add_f32 v74, v114, v114
    v_add_f32 v75, v115, v115
    v_add_f32 v76, v116, v116
    v_add_f32 v77, v117, v117
    v_cvt_pk_bf16_f32 v56, v70, v71
    v_cvt_pk_bf16_f32 v57, v72, v73
    v_cvt_pk_bf16_f32 v58, v74, v75
    v_cvt_pk_bf16_f32 v59, v76, v77
    ds_write_b128 v23, v[56:59]
    s_waitcnt lgkmcnt(0)
    s_barrier
    ds_read_b128 v[60:63], v23 offset:16
    v_cmp_eq_u32 vcc, 255, v0
    s_waitcnt lgkmcnt(0)
    v_cndmask_b32 v60, v60, 0, vcc
    v_cndmask_b32 v61, v61, 0, vcc
    v_cndmask_b32 v62, v62, 0, vcc
    v_cndmask_b32 v63, v63, 0, vcc
    s_bitcmp1_b32 s3, 0
    s_cbranch_scc1 C_kd
    s_add_u32 s3, s3, 1
    v_mov_b32 v200, v205
    v_mov_b32 v201, v206
    v_mov_b32 v202, v207
    v_mov_b32 v203, v208
    v_mov_b32 v204, v209
    v_mov_b32 v212, v56
    v_mov_b32 v213, v57
    v_mov_b32 v214, v58
    v_mov_b32 v215, v59
    v_mov_b32 v216, v60
    v_mov_b32 v217, v61
    v_mov_b32 v218, v62
    v_mov_b32 v219, v63
    s_branch C_kg
C_kd:
    s_setprio 1
    v_mov_b32 v100, v212
    v_mov_b32 v124, v56
    v_mov_b32 v108, 0
    v_mov_b32 v132, 0
    v_mov_b32 v101, v213
    v_mov_b32 v125, v57
    v_mov_b32 v109, 0
    v_mov_b32 v133, 0
    v_mov_b32 v102, v214
    v_mov_b32 v126, v58
    v_mov_b32 v110, 0
    v_mov_b32 v134, 0
    v_mov_b32 v103, v215
    v_mov_b32 v127, v59
    v_mov_b32 v111, 0
    v_mov_b32 v135, 0
    v_mov_b32 v104, v216
    v_mov_b32 v128, v60
    v_mov_b32 v112, 0
    v_mov_b32 v136, 0
    v_mov_b32 v105, v217
    v_mov_b32 v129, v61
    v_mov_b32 v113, 0
    v_mov_b32 v137, 0
    v_mov_b32 v106, v218
    v_mov_b32 v130, v62
    v_mov_b32 v114, 0
    v_mov_b32 v138, 0
    v_mov_b32 v107, v219
    v_mov_b32 v131, v63
    v_mov_b32 v115, 0
    v_mov_b32 v139, 0
    s_barrier
    s_sub_u32 s19, s67, 256
    s_mov_b32 s12, s48
    s_and_b32 s13, s49, 0xffff
    s_mov_b32 s14, 1024
    s_mov_b32 s15, 0x00020000
    s_mul_i32 s3, s19, 2
    s_mul_i32 s4, s3, 4352
    s_add_u32 s4, s4, 6291456
    s_lshl_b32 s5, s3, 12
    s_add_u32 s6, s5, 2097152
    s_add_u32 s7, s5, 4194304
    v_lshlrev_b32 v1, 4, v0
    v_add_u32 v2, 4096, v1
    s_lshl_b32 s5, s3, 1
    v_mov_b32 v3, s5
    s_add_u32 s20, s4, 0
    s_add_u32 s21, s6, 0
    buffer_load_ushort v120, v3, s[12:15], 0 offen offset:0
    s_add_u32 s20, s4, 4352
    s_add_u32 s21, s6, 4096
    buffer_load_ushort v144, v3, s[12:15], 0 offen offset:2
    v_mov_b32 v36, 0
    v_mov_b32 v37, 0
    v_mov_b32 v38, 0
    v_mov_b32 v39, 0
    v_cmp_gt_u32 vcc, 160, v0
    s_and_saveexec_b64 s[16:17], vcc
    ds_write_b128 v1, v[36:39] offset:35328
    s_mov_b64 exec, s[16:17]
    v_lshrrev_b32 v4, 2, v0
    v_mul_u32_u24 v4, 80, v4
    v_and_b32 v5, 3, v0
    v_lshl_add_u32 v4, v5, 4, v4
    v_and_b32 v6, 31, v0
    v_bfe_u32 v7, v0, 5, 1
    v_sub_u32 v8, 7, v6
    v_and_b32 v8, 7, v8
    v_mul_u32_u24 v8, 4416, v8
    v_sub_u32 v9, 2047, v6
    v_lshrrev_b32 v9, 3, v9
    v_add_u32 v9, v9, v7
    v_lshl_add_u32 v8, v9, 4, v8
    v_subrev_u32 v8, 4032, v8
    v_mul_u32_u24 v9, 80, v6
    v_lshl_add_u32 v9, v7, 4, v9
    v_add_u32 v9, 32848, v9
    v_lshrrev_b32 v10, 6, v0
    v_and_b32 v11, 63, v0
    v_lshlrev_b32 v11, 4, v11
    v_readfirstlane_b32 s18, v10
    v_lshl_add_u32 v96, v10, 13, v11
    v_lshrrev_b32 v12, 1, v10
    v_and_b32 v13, 1, v10
    v_lshl_add_u32 v97, v12, 12, v11
    v_lshl_add_u32 v97, v13, 11, v97
    v_add_u32 v98, 24576, v97
    v_cmp_eq_u32 vcc, 0, v12
    v_add_u32 v99, 35328, v11
    s_nop 0
    v_cndmask_b32 v98, v98, v99, vcc
    v_lshl_add_u32 v14, v12, 5, v6
    v_mul_u32_u24 v15, 80, v14
    v_lshl_add_u32 v15, v7, 3, v15
    v_lshl_add_u32 v15, v13, 5, v15
    v_lshlrev_b32 v14, 6, v14
    v_lshl_add_u32 v14, v7, 3, v14
    v_lshl_add_u32 v14, v13, 5, v14
    v_mov_b32 v64, 0
    v_mov_b32 v65, 0
    v_mov_b32 v66, 0
    v_mov_b32 v67, 0
    v_mov_b32 v68, 0
    v_mov_b32 v69, 0
    v_mov_b32 v70, 0
    v_mov_b32 v71, 0
    v_mov_b32 v72, 0
    v_mov_b32 v73, 0
    v_mov_b32 v74, 0
    v_mov_b32 v75, 0
    v_mov_b32 v76, 0
    v_mov_b32 v77, 0
    v_mov_b32 v78, 0
    v_mov_b32 v79, 0
    v_mov_b32 v80, 0
    v_mov_b32 v81, 0
    v_mov_b32 v82, 0
    v_mov_b32 v83, 0
    v_mov_b32 v84, 0
    v_mov_b32 v85, 0
    v_mov_b32 v86, 0
    v_mov_b32 v87, 0
    v_mov_b32 v88, 0
    v_mov_b32 v89, 0
    v_mov_b32 v90, 0
    v_mov_b32 v91, 0
    v_mov_b32 v92, 0
    v_mov_b32 v93, 0
    v_mov_b32 v94, 0
    v_mov_b32 v95, 0
    s_waitcnt vmcnt(0)
    s_mov_b32 s24, 0x05040100
    s_mov_b32 s25, 0x07060302
    v_perm_b32 v116, v161, v160, s24
    v_perm_b32 v140, v161, v160, s25
    v_perm_b32 v117, v163, v162, s24
    v_perm_b32 v141, v163, v162, s25
    v_perm_b32 v118, v165, v164, s24
    v_perm_b32 v142, v165, v164, s25
    v_perm_b32 v119, v167, v166, s24
    v_perm_b32 v143, v167, v166, s25
    ds_write_b128 v1, v[100:103]
    ds_write_b128 v1, v[102:105] offset:17664
    v_alignbit_b32 v40, v101, v100, 16
    v_alignbit_b32 v44, v102, v101, 16
    v_alignbit_b32 v48, v103, v102, 16
    v_alignbit_b32 v52, v104, v103, 16
    v_mov_b32 v56, v101
    v_mov_b32 v60, v103
    v_alignbit_b32 v41, v102, v101, 16
    v_alignbit_b32 v45, v103, v102, 16
    v_alignbit_b32 v49, v104, v103, 16
    v_alignbit_b32 v53, v105, v104, 16
    v_mov_b32 v57, v102
    v_mov_b32 v61, v104
    v_alignbit_b32 v42, v103, v102, 16
    v_alignbit_b32 v46, v104, v103, 16
    v_alignbit_b32 v50, v105, v104, 16
    v_alignbit_b32 v54, v106, v105, 16
    v_mov_b32 v58, v103
    v_mov_b32 v62, v105
    v_alignbit_b32 v43, v104, v103, 16
    v_alignbit_b32 v47, v105, v104, 16
    v_alignbit_b32 v51, v106, v105, 16
    v_alignbit_b32 v55, v107, v106, 16
    v_mov_b32 v59, v104
    v_mov_b32 v63, v106
    ds_write_b128 v1, v[40:43] offset:4416
    ds_write_b128 v1, v[44:47] offset:13248
    ds_write_b128 v1, v[48:51] offset:22080
    ds_write_b128 v1, v[52:55] offset:30912
    ds_write_b128 v1, v[56:59] offset:8832
    ds_write_b128 v1, v[60:63] offset:26496
    ds_write_b128 v4, v[116:119] offset:37888
    v_cmp_gt_u32 vcc, 8, v0
    s_and_saveexec_b64 s[16:17], vcc
    ds_write_b128 v2, v[108:111]
    ds_write_b128 v2, v[110:113] offset:17664
    v_alignbit_b32 v40, v109, v108, 16
    v_alignbit_b32 v44, v110, v109, 16
    v_alignbit_b32 v48, v111, v110, 16
    v_alignbit_b32 v52, v112, v111, 16
    v_mov_b32 v56, v109
    v_mov_b32 v60, v111
    v_alignbit_b32 v41, v110, v109, 16
    v_alignbit_b32 v45, v111, v110, 16
    v_alignbit_b32 v49, v112, v111, 16
    v_alignbit_b32 v53, v113, v112, 16
    v_mov_b32 v57, v110
    v_mov_b32 v61, v112
    v_alignbit_b32 v42, v111, v110, 16
    v_alignbit_b32 v46, v112, v111, 16
    v_alignbit_b32 v50, v113, v112, 16
    v_alignbit_b32 v54, v114, v113, 16
    v_mov_b32 v58, v111
    v_mov_b32 v62, v113
    v_alignbit_b32 v43, v112, v111, 16
    v_alignbit_b32 v47, v113, v112, 16
    v_alignbit_b32 v51, v114, v113, 16
    v_alignbit_b32 v55, v115, v114, 16
    v_mov_b32 v59, v112
    v_mov_b32 v63, v114
    ds_write_b128 v2, v[40:43] offset:4416
    ds_write_b128 v2, v[44:47] offset:13248
    ds_write_b128 v2, v[48:51] offset:22080
    ds_write_b128 v2, v[52:55] offset:30912
    ds_write_b128 v2, v[56:59] offset:8832
    ds_write_b128 v2, v[60:63] offset:26496
    s_mov_b64 exec, s[16:17]
    v_lshlrev_b32 v120, 16, v120
    s_waitcnt lgkmcnt(0)
    s_barrier
C0_w0:
    s_cmp_lg_u32 s18, 0
    s_cbranch_scc1 C0_w1
    ds_read_b128 v[16:19], v8 offset:4032
    ds_read_b128 v[20:23], v9 offset:7600
    ds_read_b128 v[24:27], v9 offset:5040
    ds_read_b128 v[28:31], v8 offset:4064
    ds_read_b128 v[32:35], v9 offset:7632
    ds_read_b128 v[36:39], v9 offset:5072
    ds_read_b128 v[40:43], v8 offset:3968
    ds_read_b128 v[44:47], v9 offset:7520
    ds_read_b128 v[48:51], v9 offset:4960
    s_waitcnt lgkmcnt(6)
    v_mfma_f32_32x32x16_bf16 v[80:95], v[16:19], v[20:23], v[80:95]
    v_mfma_f32_32x32x16_bf16 v[64:79], v[16:19], v[24:27], v[64:79]
    ds_read_b128 v[52:55], v8 offset:4000
    ds_read_b128 v[56:59], v9 offset:7552
    ds_read_b128 v[60:63], v9 offset:4992
    s_waitcnt lgkmcnt(6)
    v_mfma_f32_32x32x16_bf16 v[80:95], v[28:31], v[32:35], v[80:95]
    v_mfma_f32_32x32x16_bf16 v[64:79], v[28:31], v[36:39], v[64:79]
    ds_read_b128 v[16:19], v8 offset:3904
    ds_read_b128 v[20:23], v9 offset:7440
    ds_read_b128 v[24:27], v9 offset:4880
    s_waitcnt lgkmcnt(6)
    v_mfma_f32_32x32x16_bf16 v[80:95], v[40:43], v[44:47], v[80:95]
    v_mfma_f32_32x32x16_bf16 v[64:79], v[40:43], v[48:51], v[64:79]
    ds_read_b128 v[28:31], v8 offset:3936
    ds_read_b128 v[32:35], v9 offset:7472
    ds_read_b128 v[36:39], v9 offset:4912
    s_waitcnt lgkmcnt(6)
    v_mfma_f32_32x32x16_bf16 v[80:95], v[52:55], v[56:59], v[80:95]
    v_mfma_f32_32x32x16_bf16 v[64:79], v[52:55], v[60:63], v[64:79]
    ds_read_b128 v[40:43], v8 offset:3840
    ds_read_b128 v[44:47], v9 offset:7360
    ds_read_b128 v[48:51], v9 offset:4800
    s_waitcnt lgkmcnt(6)
    v_mfma_f32_32x32x16_bf16 v[80:95], v[16:19], v[20:23], v[80:95]
    v_mfma_f32_32x32x16_bf16 v[64:79], v[16:19], v[24:27], v[64:79]
    ds_read_b128 v[52:55], v8 offset:3872
    ds_read_b128 v[56:59], v9 offset:7392
    ds_read_b128 v[60:63], v9 offset:4832
    s_waitcnt lgkmcnt(6)
    v_mfma_f32_32x32x16_bf16 v[80:95], v[28:31], v[32:35], v[80:95]
    v_mfma_f32_32x32x16_bf16 v[64:79], v[28:31], v[36:39], v[64:79]
    ds_read_b128 v[16:19], v8 offset:3776
    ds_read_b128 v[20:23], v9 offset:7280
    ds_read_b128 v[24:27], v9 offset:4720
    s_waitcnt lgkmcnt(6)
    v_mfma_f32_32x32x16_bf16 v[80:95], v[40:43], v[44:47], v[80:95]
    v_mfma_f32_32x32x16_bf16 v[64:79], v[40:43], v[48:51], v[64:79]
    ds_read_b128 v[28:31], v8 offset:3808
    ds_read_b128 v[32:35], v9 offset:7312
    ds_read_b128 v[36:39], v9 offset:4752
    s_waitcnt lgkmcnt(6)
    v_mfma_f32_32x32x16_bf16 v[80:95], v[52:55], v[56:59], v[80:95]
    v_mfma_f32_32x32x16_bf16 v[64:79], v[52:55], v[60:63], v[64:79]
    ds_read_b128 v[40:43], v8 offset:3712
    ds_read_b128 v[44:47], v9 offset:7200
    ds_read_b128 v[48:51], v9 offset:4640
    s_waitcnt lgkmcnt(6)
    v_mfma_f32_32x32x16_bf16 v[80:95], v[16:19], v[20:23], v[80:95]
    v_mfma_f32_32x32x16_bf16 v[64:79], v[16:19], v[24:27], v[64:79]
    ds_read_b128 v[52:55], v8 offset:3744
    ds_read_b128 v[56:59], v9 offset:7232
    ds_read_b128 v[60:63], v9 offset:4672
    s_waitcnt lgkmcnt(6)
    v_mfma_f32_32x32x16_bf16 v[80:95], v[28:31], v[32:35], v[80:95]
    v_mfma_f32_32x32x16_bf16 v[64:79], v[28:31], v[36:39], v[64:79]
    ds_read_b128 v[16:19], v8 offset:3648
    ds_read_b128 v[20:23], v9 offset:7120
    ds_read_b128 v[24:27], v9 offset:4560
    s_waitcnt lgkmcnt(6)
    v_mfma_f32_32x32x16_bf16 v[80:95], v[40:43], v[44:47], v[80:95]
    v_mfma_f32_32x32x16_bf16 v[64:79], v[40:43], v[48:51], v[64:79]
    ds_read_b128 v[28:31], v8 offset:3680
    ds_read_b128 v[32:35], v9 offset:7152
    ds_read_b128 v[36:39], v9 offset:4592
    s_waitcnt lgkmcnt(6)
    v_mfma_f32_32x32x16_bf16 v[80:95], v[52:55], v[56:59], v[80:95]
    v_mfma_f32_32x32x16_bf16 v[64:79], v[52:55], v[60:63], v[64:79]
    ds_read_b128 v[40:43], v8 offset:3584
    ds_read_b128 v[44:47], v9 offset:7040
    ds_read_b128 v[48:51], v9 offset:4480
    s_waitcnt lgkmcnt(6)
    v_mfma_f32_32x32x16_bf16 v[80:95], v[16:19], v[20:23], v[80:95]
    v_mfma_f32_32x32x16_bf16 v[64:79], v[16:19], v[24:27], v[64:79]
    ds_read_b128 v[52:55], v8 offset:3616
    ds_read_b128 v[56:59], v9 offset:7072
    ds_read_b128 v[60:63], v9 offset:4512
    s_waitcnt lgkmcnt(6)
    v_mfma_f32_32x32x16_bf16 v[80:95], v[28:31], v[32:35], v[80:95]
    v_mfma_f32_32x32x16_bf16 v[64:79], v[28:31], v[36:39], v[64:79]
    ds_read_b128 v[16:19], v8 offset:3520
    ds_read_b128 v[20:23], v9 offset:6960
    ds_read_b128 v[24:27], v9 offset:4400
    s_waitcnt lgkmcnt(6)
    v_mfma_f32_32x32x16_bf16 v[80:95], v[40:43], v[44:47], v[80:95]
    v_mfma_f32_32x32x16_bf16 v[64:79], v[40:43], v[48:51], v[64:79]
    ds_read_b128 v[28:31], v8 offset:3552
    ds_read_b128 v[32:35], v9 offset:6992
    ds_read_b128 v[36:39], v9 offset:4432
    s_waitcnt lgkmcnt(6)
    v_mfma_f32_32x32x16_bf16 v[80:95], v[52:55], v[56:59], v[80:95]
    v_mfma_f32_32x32x16_bf16 v[64:79], v[52:55], v[60:63], v[64:79]
    ds_read_b128 v[40:43], v8 offset:3456
    ds_read_b128 v[44:47], v9 offset:6880
    ds_read_b128 v[48:51], v9 offset:4320
    s_waitcnt lgkmcnt(6)
    v_mfma_f32_32x32x16_bf16 v[80:95], v[16:19], v[20:23], v[80:95]
    v_mfma_f32_32x32x16_bf16 v[64:79], v[16:19], v[24:27], v[64:79]
    ds_read_b128 v[52:55], v8 offset:3488
    ds_read_b128 v[56:59], v9 offset:6912
    ds_read_b128 v[60:63], v9 offset:4352
    s_waitcnt lgkmcnt(6)
    v_mfma_f32_32x32x16_bf16 v[80:95], v[28:31], v[32:35], v[80:95]
    v_mfma_f32_32x32x16_bf16 v[64:79], v[28:31], v[36:39], v[64:79]
    ds_read_b128 v[16:19], v8 offset:3392
    ds_read_b128 v[20:23], v9 offset:6800
    ds_read_b128 v[24:27], v9 offset:4240
    s_waitcnt lgkmcnt(6)
    v_mfma_f32_32x32x16_bf16 v[80:95], v[40:43], v[44:47], v[80:95]
    v_mfma_f32_32x32x16_bf16 v[64:79], v[40:43], v[48:51], v[64:79]
    ds_read_b128 v[28:31], v8 offset:3424
    ds_read_b128 v[32:35], v9 offset:6832
    ds_read_b128 v[36:39], v9 offset:4272
    s_waitcnt lgkmcnt(6)
    v_mfma_f32_32x32x16_bf16 v[80:95], v[52:55], v[56:59], v[80:95]
    v_mfma_f32_32x32x16_bf16 v[64:79], v[52:55], v[60:63], v[64:79]
    ds_read_b128 v[40:43], v8 offset:3328
    ds_read_b128 v[44:47], v9 offset:6720
    ds_read_b128 v[48:51], v9 offset:4160
    s_waitcnt lgkmcnt(6)
    v_mfma_f32_32x32x16_bf16 v[80:95], v[16:19], v[20:23], v[80:95]
    v_mfma_f32_32x32x16_bf16 v[64:79], v[16:19], v[24:27], v[64:79]
    ds_read_b128 v[52:55], v8 offset:3360
    ds_read_b128 v[56:59], v9 offset:6752
    ds_read_b128 v[60:63], v9 offset:4192
    s_waitcnt lgkmcnt(6)
    v_mfma_f32_32x32x16_bf16 v[80:95], v[28:31], v[32:35], v[80:95]
    v_mfma_f32_32x32x16_bf16 v[64:79], v[28:31], v[36:39], v[64:79]
    s_waitcnt lgkmcnt(3)
    v_mfma_f32_32x32x16_bf16 v[80:95], v[40:43], v[44:47], v[80:95]
    v_mfma_f32_32x32x16_bf16 v[64:79], v[40:43], v[48:51], v[64:79]
    s_waitcnt lgkmcnt(0)
    v_mfma_f32_32x32x16_bf16 v[80:95], v[52:55], v[56:59], v[80:95]
    v_mfma_f32_32x32x16_bf16 v[64:79], v[52:55], v[60:63], v[64:79]
    s_branch C0_red
C0_w1:
    s_cmp_lg_u32 s18, 1
    s_cbranch_scc1 C0_w2
    ds_read_b128 v[16:19], v8 offset:3264
    ds_read_b128 v[20:23], v9 offset:6640
    ds_read_b128 v[24:27], v9 offset:4080
    ds_read_b128 v[28:31], v8 offset:3296
    ds_read_b128 v[32:35], v9 offset:6672
    ds_read_b128 v[36:39], v9 offset:4112
    ds_read_b128 v[40:43], v8 offset:3200
    ds_read_b128 v[44:47], v9 offset:6560
    ds_read_b128 v[48:51], v9 offset:4000
    s_waitcnt lgkmcnt(6)
    v_mfma_f32_32x32x16_bf16 v[80:95], v[16:19], v[20:23], v[80:95]
    v_mfma_f32_32x32x16_bf16 v[64:79], v[16:19], v[24:27], v[64:79]
    ds_read_b128 v[52:55], v8 offset:3232
    ds_read_b128 v[56:59], v9 offset:6592
    ds_read_b128 v[60:63], v9 offset:4032
    s_waitcnt lgkmcnt(6)
    v_mfma_f32_32x32x16_bf16 v[80:95], v[28:31], v[32:35], v[80:95]
    v_mfma_f32_32x32x16_bf16 v[64:79], v[28:31], v[36:39], v[64:79]
    ds_read_b128 v[16:19], v8 offset:3136
    ds_read_b128 v[20:23], v9 offset:6480
    ds_read_b128 v[24:27], v9 offset:3920
    s_waitcnt lgkmcnt(6)
    v_mfma_f32_32x32x16_bf16 v[80:95], v[40:43], v[44:47], v[80:95]
    v_mfma_f32_32x32x16_bf16 v[64:79], v[40:43], v[48:51], v[64:79]
    ds_read_b128 v[28:31], v8 offset:3168
    ds_read_b128 v[32:35], v9 offset:6512
    ds_read_b128 v[36:39], v9 offset:3952
    s_waitcnt lgkmcnt(6)
    v_mfma_f32_32x32x16_bf16 v[80:95], v[52:55], v[56:59], v[80:95]
    v_mfma_f32_32x32x16_bf16 v[64:79], v[52:55], v[60:63], v[64:79]
    ds_read_b128 v[40:43], v8 offset:3072
    ds_read_b128 v[44:47], v9 offset:6400
    ds_read_b128 v[48:51], v9 offset:3840
    s_waitcnt lgkmcnt(6)
    v_mfma_f32_32x32x16_bf16 v[80:95], v[16:19], v[20:23], v[80:95]
    v_mfma_f32_32x32x16_bf16 v[64:79], v[16:19], v[24:27], v[64:79]
    ds_read_b128 v[52:55], v8 offset:3104
    ds_read_b128 v[56:59], v9 offset:6432
    ds_read_b128 v[60:63], v9 offset:3872
    s_waitcnt lgkmcnt(6)
    v_mfma_f32_32x32x16_bf16 v[80:95], v[28:31], v[32:35], v[80:95]
    v_mfma_f32_32x32x16_bf16 v[64:79], v[28:31], v[36:39], v[64:79]
    ds_read_b128 v[16:19], v8 offset:3008
    ds_read_b128 v[20:23], v9 offset:6320
    ds_read_b128 v[24:27], v9 offset:3760
    s_waitcnt lgkmcnt(6)
    v_mfma_f32_32x32x16_bf16 v[80:95], v[40:43], v[44:47], v[80:95]
    v_mfma_f32_32x32x16_bf16 v[64:79], v[40:43], v[48:51], v[64:79]
    ds_read_b128 v[28:31], v8 offset:3040
    ds_read_b128 v[32:35], v9 offset:6352
    ds_read_b128 v[36:39], v9 offset:3792
    s_waitcnt lgkmcnt(6)
    v_mfma_f32_32x32x16_bf16 v[80:95], v[52:55], v[56:59], v[80:95]
    v_mfma_f32_32x32x16_bf16 v[64:79], v[52:55], v[60:63], v[64:79]
    ds_read_b128 v[40:43], v8 offset:2944
    ds_read_b128 v[44:47], v9 offset:6240
    ds_read_b128 v[48:51], v9 offset:3680
    s_waitcnt lgkmcnt(6)
    v_mfma_f32_32x32x16_bf16 v[80:95], v[16:19], v[20:23], v[80:95]
    v_mfma_f32_32x32x16_bf16 v[64:79], v[16:19], v[24:27], v[64:79]
    ds_read_b128 v[52:55], v8 offset:2976
    ds_read_b128 v[56:59], v9 offset:6272
    ds_read_b128 v[60:63], v9 offset:3712
    s_waitcnt lgkmcnt(6)
    v_mfma_f32_32x32x16_bf16 v[80:95], v[28:31], v[32:35], v[80:95]
    v_mfma_f32_32x32x16_bf16 v[64:79], v[28:31], v[36:39], v[64:79]
    ds_read_b128 v[16:19], v8 offset:2880
    ds_read_b128 v[20:23], v9 offset:6160
    ds_read_b128 v[24:27], v9 offset:3600
    s_waitcnt lgkmcnt(6)
    v_mfma_f32_32x32x16_bf16 v[80:95], v[40:43], v[44:47], v[80:95]
    v_mfma_f32_32x32x16_bf16 v[64:79], v[40:43], v[48:51], v[64:79]
    ds_read_b128 v[28:31], v8 offset:2912
    ds_read_b128 v[32:35], v9 offset:6192
    ds_read_b128 v[36:39], v9 offset:3632
    s_waitcnt lgkmcnt(6)
    v_mfma_f32_32x32x16_bf16 v[80:95], v[52:55], v[56:59], v[80:95]
    v_mfma_f32_32x32x16_bf16 v[64:79], v[52:55], v[60:63], v[64:79]
    ds_read_b128 v[40:43], v8 offset:2816
    ds_read_b128 v[44:47], v9 offset:6080
    ds_read_b128 v[48:51], v9 offset:3520
    s_waitcnt lgkmcnt(6)
    v_mfma_f32_32x32x16_bf16 v[80:95], v[16:19], v[20:23], v[80:95]
    v_mfma_f32_32x32x16_bf16 v[64:79], v[16:19], v[24:27], v[64:79]
    ds_read_b128 v[52:55], v8 offset:2848
    ds_read_b128 v[56:59], v9 offset:6112
    ds_read_b128 v[60:63], v9 offset:3552
    s_waitcnt lgkmcnt(6)
    v_mfma_f32_32x32x16_bf16 v[80:95], v[28:31], v[32:35], v[80:95]
    v_mfma_f32_32x32x16_bf16 v[64:79], v[28:31], v[36:39], v[64:79]
    ds_read_b128 v[16:19], v8 offset:2752
    ds_read_b128 v[20:23], v9 offset:6000
    ds_read_b128 v[24:27], v9 offset:3440
    s_waitcnt lgkmcnt(6)
    v_mfma_f32_32x32x16_bf16 v[80:95], v[40:43], v[44:47], v[80:95]
    v_mfma_f32_32x32x16_bf16 v[64:79], v[40:43], v[48:51], v[64:79]
    ds_read_b128 v[28:31], v8 offset:2784
    ds_read_b128 v[32:35], v9 offset:6032
    ds_read_b128 v[36:39], v9 offset:3472
    s_waitcnt lgkmcnt(6)
    v_mfma_f32_32x32x16_bf16 v[80:95], v[52:55], v[56:59], v[80:95]
    v_mfma_f32_32x32x16_bf16 v[64:79], v[52:55], v[60:63], v[64:79]
    ds_read_b128 v[40:43], v8 offset:2688
    ds_read_b128 v[44:47], v9 offset:5920
    ds_read_b128 v[48:51], v9 offset:3360
    s_waitcnt lgkmcnt(6)
    v_mfma_f32_32x32x16_bf16 v[80:95], v[16:19], v[20:23], v[80:95]
    v_mfma_f32_32x32x16_bf16 v[64:79], v[16:19], v[24:27], v[64:79]
    ds_read_b128 v[52:55], v8 offset:2720
    ds_read_b128 v[56:59], v9 offset:5952
    ds_read_b128 v[60:63], v9 offset:3392
    s_waitcnt lgkmcnt(6)
    v_mfma_f32_32x32x16_bf16 v[80:95], v[28:31], v[32:35], v[80:95]
    v_mfma_f32_32x32x16_bf16 v[64:79], v[28:31], v[36:39], v[64:79]
    ds_read_b128 v[16:19], v8 offset:2624
    ds_read_b128 v[20:23], v9 offset:5840
    ds_read_b128 v[24:27], v9 offset:3280
    s_waitcnt lgkmcnt(6)
    v_mfma_f32_32x32x16_bf16 v[80:95], v[40:43], v[44:47], v[80:95]
    v_mfma_f32_32x32x16_bf16 v[64:79], v[40:43], v[48:51], v[64:79]
    ds_read_b128 v[28:31], v8 offset:2656
    ds_read_b128 v[32:35], v9 offset:5872
    ds_read_b128 v[36:39], v9 offset:3312
    s_waitcnt lgkmcnt(6)
    v_mfma_f32_32x32x16_bf16 v[80:95], v[52:55], v[56:59], v[80:95]
    v_mfma_f32_32x32x16_bf16 v[64:79], v[52:55], v[60:63], v[64:79]
    ds_read_b128 v[40:43], v8 offset:2560
    ds_read_b128 v[44:47], v9 offset:5760
    ds_read_b128 v[48:51], v9 offset:3200
    s_waitcnt lgkmcnt(6)
    v_mfma_f32_32x32x16_bf16 v[80:95], v[16:19], v[20:23], v[80:95]
    v_mfma_f32_32x32x16_bf16 v[64:79], v[16:19], v[24:27], v[64:79]
    ds_read_b128 v[52:55], v8 offset:2592
    ds_read_b128 v[56:59], v9 offset:5792
    ds_read_b128 v[60:63], v9 offset:3232
    s_waitcnt lgkmcnt(6)
    v_mfma_f32_32x32x16_bf16 v[80:95], v[28:31], v[32:35], v[80:95]
    v_mfma_f32_32x32x16_bf16 v[64:79], v[28:31], v[36:39], v[64:79]
    s_waitcnt lgkmcnt(3)
    v_mfma_f32_32x32x16_bf16 v[80:95], v[40:43], v[44:47], v[80:95]
    v_mfma_f32_32x32x16_bf16 v[64:79], v[40:43], v[48:51], v[64:79]
    s_waitcnt lgkmcnt(0)
    v_mfma_f32_32x32x16_bf16 v[80:95], v[52:55], v[56:59], v[80:95]
    v_mfma_f32_32x32x16_bf16 v[64:79], v[52:55], v[60:63], v[64:79]
    s_branch C0_red
C0_w2:
    s_cmp_lg_u32 s18, 2
    s_cbranch_scc1 C0_w3
    ds_read_b128 v[16:19], v8 offset:2496
    ds_read_b128 v[20:23], v9 offset:5680
    ds_read_b128 v[24:27], v9 offset:3120
    ds_read_b128 v[28:31], v8 offset:2528
    ds_read_b128 v[32:35], v9 offset:5712
    ds_read_b128 v[36:39], v9 offset:3152
    ds_read_b128 v[40:43], v8 offset:2432
    ds_read_b128 v[44:47], v9 offset:5600
    ds_read_b128 v[48:51], v9 offset:3040
    s_waitcnt lgkmcnt(6)
    v_mfma_f32_32x32x16_bf16 v[80:95], v[16:19], v[20:23], v[80:95]
    v_mfma_f32_32x32x16_bf16 v[64:79], v[16:19], v[24:27], v[64:79]
    ds_read_b128 v[52:55], v8 offset:2464
    ds_read_b128 v[56:59], v9 offset:5632
    ds_read_b128 v[60:63], v9 offset:3072
    s_waitcnt lgkmcnt(6)
    v_mfma_f32_32x32x16_bf16 v[80:95], v[28:31], v[32:35], v[80:95]
    v_mfma_f32_32x32x16_bf16 v[64:79], v[28:31], v[36:39], v[64:79]
    ds_read_b128 v[16:19], v8 offset:2368
    ds_read_b128 v[20:23], v9 offset:5520
    ds_read_b128 v[24:27], v9 offset:2960
    s_waitcnt lgkmcnt(6)
    v_mfma_f32_32x32x16_bf16 v[80:95], v[40:43], v[44:47], v[80:95]
    v_mfma_f32_32x32x16_bf16 v[64:79], v[40:43], v[48:51], v[64:79]
    ds_read_b128 v[28:31], v8 offset:2400
    ds_read_b128 v[32:35], v9 offset:5552
    ds_read_b128 v[36:39], v9 offset:2992
    s_waitcnt lgkmcnt(6)
    v_mfma_f32_32x32x16_bf16 v[80:95], v[52:55], v[56:59], v[80:95]
    v_mfma_f32_32x32x16_bf16 v[64:79], v[52:55], v[60:63], v[64:79]
    ds_read_b128 v[40:43], v8 offset:2304
    ds_read_b128 v[44:47], v9 offset:5440
    ds_read_b128 v[48:51], v9 offset:2880
    s_waitcnt lgkmcnt(6)
    v_mfma_f32_32x32x16_bf16 v[80:95], v[16:19], v[20:23], v[80:95]
    v_mfma_f32_32x32x16_bf16 v[64:79], v[16:19], v[24:27], v[64:79]
    ds_read_b128 v[52:55], v8 offset:2336
    ds_read_b128 v[56:59], v9 offset:5472
    ds_read_b128 v[60:63], v9 offset:2912
    s_waitcnt lgkmcnt(6)
    v_mfma_f32_32x32x16_bf16 v[80:95], v[28:31], v[32:35], v[80:95]
    v_mfma_f32_32x32x16_bf16 v[64:79], v[28:31], v[36:39], v[64:79]
    ds_read_b128 v[16:19], v8 offset:2240
    ds_read_b128 v[20:23], v9 offset:5360
    ds_read_b128 v[24:27], v9 offset:2800
    s_waitcnt lgkmcnt(6)
    v_mfma_f32_32x32x16_bf16 v[80:95], v[40:43], v[44:47], v[80:95]
    v_mfma_f32_32x32x16_bf16 v[64:79], v[40:43], v[48:51], v[64:79]
    ds_read_b128 v[28:31], v8 offset:2272
    ds_read_b128 v[32:35], v9 offset:5392
    ds_read_b128 v[36:39], v9 offset:2832
    s_waitcnt lgkmcnt(6)
    v_mfma_f32_32x32x16_bf16 v[80:95], v[52:55], v[56:59], v[80:95]
    v_mfma_f32_32x32x16_bf16 v[64:79], v[52:55], v[60:63], v[64:79]
    ds_read_b128 v[40:43], v8 offset:2176
    ds_read_b128 v[44:47], v9 offset:5280
    ds_read_b128 v[48:51], v9 offset:2720
    s_waitcnt lgkmcnt(6)
    v_mfma_f32_32x32x16_bf16 v[80:95], v[16:19], v[20:23], v[80:95]
    v_mfma_f32_32x32x16_bf16 v[64:79], v[16:19], v[24:27], v[64:79]
    ds_read_b128 v[52:55], v8 offset:2208
    ds_read_b128 v[56:59], v9 offset:5312
    ds_read_b128 v[60:63], v9 offset:2752
    s_waitcnt lgkmcnt(6)
    v_mfma_f32_32x32x16_bf16 v[80:95], v[28:31], v[32:35], v[80:95]
    v_mfma_f32_32x32x16_bf16 v[64:79], v[28:31], v[36:39], v[64:79]
    ds_read_b128 v[16:19], v8 offset:2112
    ds_read_b128 v[20:23], v9 offset:5200
    ds_read_b128 v[24:27], v9 offset:2640
    s_waitcnt lgkmcnt(6)
    v_mfma_f32_32x32x16_bf16 v[80:95], v[40:43], v[44:47], v[80:95]
    v_mfma_f32_32x32x16_bf16 v[64:79], v[40:43], v[48:51], v[64:79]
    ds_read_b128 v[28:31], v8 offset:2144
    ds_read_b128 v[32:35], v9 offset:5232
    ds_read_b128 v[36:39], v9 offset:2672
    s_waitcnt lgkmcnt(6)
    v_mfma_f32_32x32x16_bf16 v[80:95], v[52:55], v[56:59], v[80:95]
    v_mfma_f32_32x32x16_bf16 v[64:79], v[52:55], v[60:63], v[64:79]
    ds_read_b128 v[40:43], v8 offset:2048
    ds_read_b128 v[44:47], v9 offset:5120
    ds_read_b128 v[48:51], v9 offset:2560
    s_waitcnt lgkmcnt(6)
    v_mfma_f32_32x32x16_bf16 v[80:95], v[16:19], v[20:23], v[80:95]
    v_mfma_f32_32x32x16_bf16 v[64:79], v[16:19], v[24:27], v[64:79]
    ds_read_b128 v[52:55], v8 offset:2080
    ds_read_b128 v[56:59], v9 offset:5152
    ds_read_b128 v[60:63], v9 offset:2592
    s_waitcnt lgkmcnt(6)
    v_mfma_f32_32x32x16_bf16 v[80:95], v[28:31], v[32:35], v[80:95]
    v_mfma_f32_32x32x16_bf16 v[64:79], v[28:31], v[36:39], v[64:79]
    ds_read_b128 v[16:19], v8 offset:1984
    ds_read_b128 v[20:23], v9 offset:5040
    s_waitcnt lgkmcnt(5)
    v_mfma_f32_32x32x16_bf16 v[80:95], v[40:43], v[44:47], v[80:95]
    v_mfma_f32_32x32x16_bf16 v[64:79], v[40:43], v[48:51], v[64:79]
    ds_read_b128 v[28:31], v8 offset:2016
    ds_read_b128 v[32:35], v9 offset:5072
    s_waitcnt lgkmcnt(4)
    v_mfma_f32_32x32x16_bf16 v[80:95], v[52:55], v[56:59], v[80:95]
    v_mfma_f32_32x32x16_bf16 v[64:79], v[52:55], v[60:63], v[64:79]
    ds_read_b128 v[40:43], v8 offset:1920
    ds_read_b128 v[44:47], v9 offset:4960
    s_waitcnt lgkmcnt(4)
    v_mfma_f32_32x32x16_bf16 v[80:95], v[16:19], v[20:23], v[80:95]
    ds_read_b128 v[52:55], v8 offset:1952
    ds_read_b128 v[56:59], v9 offset:4992
    s_waitcnt lgkmcnt(4)
    v_mfma_f32_32x32x16_bf16 v[80:95], v[28:31], v[32:35], v[80:95]
    ds_read_b128 v[16:19], v8 offset:1856
    ds_read_b128 v[20:23], v9 offset:4880
    s_waitcnt lgkmcnt(4)
    v_mfma_f32_32x32x16_bf16 v[80:95], v[40:43], v[44:47], v[80:95]
    ds_read_b128 v[28:31], v8 offset:1888
    ds_read_b128 v[32:35], v9 offset:4912
    s_waitcnt lgkmcnt(4)
    v_mfma_f32_32x32x16_bf16 v[80:95], v[52:55], v[56:59], v[80:95]
    ds_read_b128 v[40:43], v8 offset:1792
    ds_read_b128 v[44:47], v9 offset:4800
    s_waitcnt lgkmcnt(4)
    v_mfma_f32_32x32x16_bf16 v[80:95], v[16:19], v[20:23], v[80:95]
    ds_read_b128 v[52:55], v8 offset:1824
    ds_read_b128 v[56:59], v9 offset:4832
    s_waitcnt lgkmcnt(4)
    v_mfma_f32_32x32x16_bf16 v[80:95], v[28:31], v[32:35], v[80:95]
    ds_read_b128 v[16:19], v8 offset:1728
    ds_read_b128 v[20:23], v9 offset:4720
    s_waitcnt lgkmcnt(4)
    v_mfma_f32_32x32x16_bf16 v[80:95], v[40:43], v[44:47], v[80:95]
    ds_read_b128 v[28:31], v8 offset:1760
    ds_read_b128 v[32:35], v9 offset:4752
    s_waitcnt lgkmcnt(4)
    v_mfma_f32_32x32x16_bf16 v[80:95], v[52:55], v[56:59], v[80:95]
    ds_read_b128 v[40:43], v8 offset:1664
    ds_read_b128 v[44:47], v9 offset:4640
    s_waitcnt lgkmcnt(4)
    v_mfma_f32_32x32x16_bf16 v[80:95], v[16:19], v[20:23], v[80:95]
    ds_read_b128 v[52:55], v8 offset:1696
    ds_read_b128 v[56:59], v9 offset:4672
    s_waitcnt lgkmcnt(4)
    v_mfma_f32_32x32x16_bf16 v[80:95], v[28:31], v[32:35], v[80:95]
    ds_read_b128 v[16:19], v8 offset:1600
    ds_read_b128 v[20:23], v9 offset:4560
    s_waitcnt lgkmcnt(4)
    v_mfma_f32_32x32x16_bf16 v[80:95], v[40:43], v[44:47], v[80:95]
    ds_read_b128 v[28:31], v8 offset:1632
    ds_read_b128 v[32:35], v9 offset:4592
    s_waitcnt lgkmcnt(4)
    v_mfma_f32_32x32x16_bf16 v[80:95], v[52:55], v[56:59], v[80:95]
    ds_read_b128 v[40:43], v8 offset:1536
    ds_read_b128 v[44:47], v9 offset:4480
    s_waitcnt lgkmcnt(4)
    v_mfma_f32_32x32x16_bf16 v[80:95], v[16:19], v[20:23], v[80:95]
    ds_read_b128 v[52:55], v8 offset:1568
    ds_read_b128 v[56:59], v9 offset:4512
    s_waitcnt lgkmcnt(4)
    v_mfma_f32_32x32x16_bf16 v[80:95], v[28:31], v[32:35], v[80:95]
    s_waitcnt lgkmcnt(2)
    v_mfma_f32_32x32x16_bf16 v[80:95], v[40:43], v[44:47], v[80:95]
    s_waitcnt lgkmcnt(0)
    v_mfma_f32_32x32x16_bf16 v[80:95], v[52:55], v[56:59], v[80:95]
    s_branch C0_red
C0_w3:
    ds_read_b128 v[16:19], v8 offset:1472
    ds_read_b128 v[20:23], v9 offset:4400
    ds_read_b128 v[28:31], v8 offset:1504
    ds_read_b128 v[32:35], v9 offset:4432
    ds_read_b128 v[40:43], v8 offset:1408
    ds_read_b128 v[44:47], v9 offset:4320
    s_waitcnt lgkmcnt(4)
    v_mfma_f32_32x32x16_bf16 v[80:95], v[16:19], v[20:23], v[80:95]
    ds_read_b128 v[52:55], v8 offset:1440
    ds_read_b128 v[56:59], v9 offset:4352
    s_waitcnt lgkmcnt(4)
    v_mfma_f32_32x32x16_bf16 v[80:95], v[28:31], v[32:35], v[80:95]
    ds_read_b128 v[16:19], v8 offset:1344
    ds_read_b128 v[20:23], v9 offset:4240
    s_waitcnt lgkmcnt(4)
    v_mfma_f32_32x32x16_bf16 v[80:95], v[40:43], v[44:47], v[80:95]
    ds_read_b128 v[28:31], v8 offset:1376
    ds_read_b128 v[32:35], v9 offset:4272
    s_waitcnt lgkmcnt(4)
    v_mfma_f32_32x32x16_bf16 v[80:95], v[52:55], v[56:59], v[80:95]
    ds_read_b128 v[40:43], v8 offset:1280
    ds_read_b128 v[44:47], v9 offset:4160
    s_waitcnt lgkmcnt(4)
    v_mfma_f32_32x32x16_bf16 v[80:95], v[16:19], v[20:23], v[80:95]
    ds_read_b128 v[52:55], v8 offset:1312
    ds_read_b128 v[56:59], v9 offset:4192
    s_waitcnt lgkmcnt(4)
    v_mfma_f32_32x32x16_bf16 v[80:95], v[28:31], v[32:35], v[80:95]
    ds_read_b128 v[16:19], v8 offset:1216
    ds_read_b128 v[20:23], v9 offset:4080
    s_waitcnt lgkmcnt(4)
    v_mfma_f32_32x32x16_bf16 v[80:95], v[40:43], v[44:47], v[80:95]
    ds_read_b128 v[28:31], v8 offset:1248
    ds_read_b128 v[32:35], v9 offset:4112
    s_waitcnt lgkmcnt(4)
    v_mfma_f32_32x32x16_bf16 v[80:95], v[52:55], v[56:59], v[80:95]
    ds_read_b128 v[40:43], v8 offset:1152
    ds_read_b128 v[44:47], v9 offset:4000
    s_waitcnt lgkmcnt(4)
    v_mfma_f32_32x32x16_bf16 v[80:95], v[16:19], v[20:23], v[80:95]
    ds_read_b128 v[52:55], v8 offset:1184
    ds_read_b128 v[56:59], v9 offset:4032
    s_waitcnt lgkmcnt(4)
    v_mfma_f32_32x32x16_bf16 v[80:95], v[28:31], v[32:35], v[80:95]
    ds_read_b128 v[16:19], v8 offset:1088
    ds_read_b128 v[20:23], v9 offset:3920
    s_waitcnt lgkmcnt(4)
    v_mfma_f32_32x32x16_bf16 v[80:95], v[40:43], v[44:47], v[80:95]
    ds_read_b128 v[28:31], v8 offset:1120
    ds_read_b128 v[32:35], v9 offset:3952
    s_waitcnt lgkmcnt(4)
    v_mfma_f32_32x32x16_bf16 v[80:95], v[52:55], v[56:59], v[80:95]
    ds_read_b128 v[40:43], v8 offset:1024
    ds_read_b128 v[44:47], v9 offset:3840
    s_waitcnt lgkmcnt(4)
    v_mfma_f32_32x32x16_bf16 v[80:95], v[16:19], v[20:23], v[80:95]
    ds_read_b128 v[52:55], v8 offset:1056
    ds_read_b128 v[56:59], v9 offset:3872
    s_waitcnt lgkmcnt(4)
    v_mfma_f32_32x32x16_bf16 v[80:95], v[28:31], v[32:35], v[80:95]
    ds_read_b128 v[16:19], v8 offset:960
    ds_read_b128 v[20:23], v9 offset:3760
    s_waitcnt lgkmcnt(4)
    v_mfma_f32_32x32x16_bf16 v[80:95], v[40:43], v[44:47], v[80:95]
    ds_read_b128 v[28:31], v8 offset:992
    ds_read_b128 v[32:35], v9 offset:3792
    s_waitcnt lgkmcnt(4)
    v_mfma_f32_32x32x16_bf16 v[80:95], v[52:55], v[56:59], v[80:95]
    ds_read_b128 v[40:43], v8 offset:896
    ds_read_b128 v[44:47], v9 offset:3680
    s_waitcnt lgkmcnt(4)
    v_mfma_f32_32x32x16_bf16 v[80:95], v[16:19], v[20:23], v[80:95]
    ds_read_b128 v[52:55], v8 offset:928
    ds_read_b128 v[56:59], v9 offset:3712
    s_waitcnt lgkmcnt(4)
    v_mfma_f32_32x32x16_bf16 v[80:95], v[28:31], v[32:35], v[80:95]
    ds_read_b128 v[16:19], v8 offset:832
    ds_read_b128 v[20:23], v9 offset:3600
    s_waitcnt lgkmcnt(4)
    v_mfma_f32_32x32x16_bf16 v[80:95], v[40:43], v[44:47], v[80:95]
    ds_read_b128 v[28:31], v8 offset:864
    ds_read_b128 v[32:35], v9 offset:3632
    s_waitcnt lgkmcnt(4)
    v_mfma_f32_32x32x16_bf16 v[80:95], v[52:55], v[56:59], v[80:95]
    ds_read_b128 v[40:43], v8 offset:768
    ds_read_b128 v[44:47], v9 offset:3520
    s_waitcnt lgkmcnt(4)
    v_mfma_f32_32x32x16_bf16 v[80:95], v[16:19], v[20:23], v[80:95]
    ds_read_b128 v[52:55], v8 offset:800
    ds_read_b128 v[56:59], v9 offset:3552
    s_waitcnt lgkmcnt(4)
    v_mfma_f32_32x32x16_bf16 v[80:95], v[28:31], v[32:35], v[80:95]
    ds_read_b128 v[16:19], v8 offset:704
    ds_read_b128 v[20:23], v9 offset:3440
    s_waitcnt lgkmcnt(4)
    v_mfma_f32_32x32x16_bf16 v[80:95], v[40:43], v[44:47], v[80:95]
    ds_read_b128 v[28:31], v8 offset:736
    ds_read_b128 v[32:35], v9 offset:3472
    s_waitcnt lgkmcnt(4)
    v_mfma_f32_32x32x16_bf16 v[80:95], v[52:55], v[56:59], v[80:95]
    ds_read_b128 v[40:43], v8 offset:640
    ds_read_b128 v[44:47], v9 offset:3360
    s_waitcnt lgkmcnt(4)
    v_mfma_f32_32x32x16_bf16 v[80:95], v[16:19], v[20:23], v[80:95]
    ds_read_b128 v[52:55], v8 offset:672
    ds_read_b128 v[56:59], v9 offset:3392
    s_waitcnt lgkmcnt(4)
    v_mfma_f32_32x32x16_bf16 v[80:95], v[28:31], v[32:35], v[80:95]
    ds_read_b128 v[16:19], v8 offset:576
    ds_read_b128 v[20:23], v9 offset:3280
    s_waitcnt lgkmcnt(4)
    v_mfma_f32_32x32x16_bf16 v[80:95], v[40:43], v[44:47], v[80:95]
    ds_read_b128 v[28:31], v8 offset:608
    ds_read_b128 v[32:35], v9 offset:3312
    s_waitcnt lgkmcnt(4)
    v_mfma_f32_32x32x16_bf16 v[80:95], v[52:55], v[56:59], v[80:95]
    ds_read_b128 v[40:43], v8 offset:512
    ds_read_b128 v[44:47], v9 offset:3200
    s_waitcnt lgkmcnt(4)
    v_mfma_f32_32x32x16_bf16 v[80:95], v[16:19], v[20:23], v[80:95]
    ds_read_b128 v[52:55], v8 offset:544
    ds_read_b128 v[56:59], v9 offset:3232
    s_waitcnt lgkmcnt(4)
    v_mfma_f32_32x32x16_bf16 v[80:95], v[28:31], v[32:35], v[80:95]
    ds_read_b128 v[16:19], v8 offset:448
    ds_read_b128 v[20:23], v9 offset:3120
    s_waitcnt lgkmcnt(4)
    v_mfma_f32_32x32x16_bf16 v[80:95], v[40:43], v[44:47], v[80:95]
    ds_read_b128 v[28:31], v8 offset:480
    ds_read_b128 v[32:35], v9 offset:3152
    s_waitcnt lgkmcnt(4)
    v_mfma_f32_32x32x16_bf16 v[80:95], v[52:55], v[56:59], v[80:95]
    ds_read_b128 v[40:43], v8 offset:384
    ds_read_b128 v[44:47], v9 offset:3040
    s_waitcnt lgkmcnt(4)
    v_mfma_f32_32x32x16_bf16 v[80:95], v[16:19], v[20:23], v[80:95]
    ds_read_b128 v[52:55], v8 offset:416
    ds_read_b128 v[56:59], v9 offset:3072
    s_waitcnt lgkmcnt(4)
    v_mfma_f32_32x32x16_bf16 v[80:95], v[28:31], v[32:35], v[80:95]
    ds_read_b128 v[16:19], v8 offset:320
    ds_read_b128 v[20:23], v9 offset:2960
    s_waitcnt lgkmcnt(4)
    v_mfma_f32_32x32x16_bf16 v[80:95], v[40:43], v[44:47], v[80:95]
    ds_read_b128 v[28:31], v8 offset:352
    ds_read_b128 v[32:35], v9 offset:2992
    s_waitcnt lgkmcnt(4)
    v_mfma_f32_32x32x16_bf16 v[80:95], v[52:55], v[56:59], v[80:95]
    ds_read_b128 v[40:43], v8 offset:256
    ds_read_b128 v[44:47], v9 offset:2880
    s_waitcnt lgkmcnt(4)
    v_mfma_f32_32x32x16_bf16 v[80:95], v[16:19], v[20:23], v[80:95]
    ds_read_b128 v[52:55], v8 offset:288
    ds_read_b128 v[56:59], v9 offset:2912
    s_waitcnt lgkmcnt(4)
    v_mfma_f32_32x32x16_bf16 v[80:95], v[28:31], v[32:35], v[80:95]
    ds_read_b128 v[16:19], v8 offset:192
    ds_read_b128 v[20:23], v9 offset:2800
    s_waitcnt lgkmcnt(4)
    v_mfma_f32_32x32x16_bf16 v[80:95], v[40:43], v[44:47], v[80:95]
    ds_read_b128 v[28:31], v8 offset:224
    ds_read_b128 v[32:35], v9 offset:2832
    s_waitcnt lgkmcnt(4)
    v_mfma_f32_32x32x16_bf16 v[80:95], v[52:55], v[56:59], v[80:95]
    ds_read_b128 v[40:43], v8 offset:128
    ds_read_b128 v[44:47], v9 offset:2720
    s_waitcnt lgkmcnt(4)
    v_mfma_f32_32x32x16_bf16 v[80:95], v[16:19], v[20:23], v[80:95]
    ds_read_b128 v[52:55], v8 offset:160
    ds_read_b128 v[56:59], v9 offset:2752
    s_waitcnt lgkmcnt(4)
    v_mfma_f32_32x32x16_bf16 v[80:95], v[28:31], v[32:35], v[80:95]
    ds_read_b128 v[16:19], v8 offset:64
    ds_read_b128 v[20:23], v9 offset:2640
    s_waitcnt lgkmcnt(4)
    v_mfma_f32_32x32x16_bf16 v[80:95], v[40:43], v[44:47], v[80:95]
    ds_read_b128 v[28:31], v8 offset:96
    ds_read_b128 v[32:35], v9 offset:2672
    s_waitcnt lgkmcnt(4)
    v_mfma_f32_32x32x16_bf16 v[80:95], v[52:55], v[56:59], v[80:95]
    ds_read_b128 v[40:43], v8 offset:0
    ds_read_b128 v[44:47], v9 offset:2560
    s_waitcnt lgkmcnt(4)
    v_mfma_f32_32x32x16_bf16 v[80:95], v[16:19], v[20:23], v[80:95]
    ds_read_b128 v[52:55], v8 offset:32
    ds_read_b128 v[56:59], v9 offset:2592
    s_waitcnt lgkmcnt(4)
    v_mfma_f32_32x32x16_bf16 v[80:95], v[28:31], v[32:35], v[80:95]
    s_waitcnt lgkmcnt(2)
    v_mfma_f32_32x32x16_bf16 v[80:95], v[40:43], v[44:47], v[80:95]
    s_waitcnt lgkmcnt(0)
    v_mfma_f32_32x32x16_bf16 v[80:95], v[52:55], v[56:59], v[80:95]
C0_red:
    s_nop 15
    s_barrier
    s_cmp_eq_u32 s18, 3
    s_cbranch_scc1 C0_skip0
    ds_write_b128 v96, v[64:67] offset:0
    ds_write_b128 v96, v[68:71] offset:1024
    ds_write_b128 v96, v[72:75] offset:2048
    ds_write_b128 v96, v[76:79] offset:3072
C0_skip0:
    ds_write_b128 v96, v[80:83] offset:4096
    ds_write_b128 v96, v[84:87] offset:5120
    ds_write_b128 v96, v[88:91] offset:6144
    ds_write_b128 v96, v[92:95] offset:7168
    s_waitcnt lgkmcnt(0)
    s_barrier
    ds_read_b128 v[16:19], v97 offset:0
    ds_read_b128 v[20:23], v97 offset:1024
    ds_read_b128 v[24:27], v97 offset:8192
    ds_read_b128 v[28:31], v97 offset:9216
    ds_read_b128 v[32:35], v97 offset:16384
    ds_read_b128 v[36:39], v97 offset:17408
    ds_read_b128 v[40:43], v98 offset:0
    ds_read_b128 v[44:47], v98 offset:1024
    ds_read_b64 v[48:49], v15 offset:37888
    ds_read_b64 v[50:51], v15 offset:37904
    s_add_u32 s20, s7, 0
    s_waitcnt lgkmcnt(0)
    v_add_f32 v16, v16, v24
    v_add_f32 v32, v32, v40
    v_add_f32 v16, v16, v32
    v_add_f32 v17, v17, v25
    v_add_f32 v33, v33, v41
    v_add_f32 v17, v17, v33
    v_add_f32 v18, v18, v26
    v_add_f32 v34, v34, v42
    v_add_f32 v18, v18, v34
    v_add_f32 v19, v19, v27
    v_add_f32 v35, v35, v43
    v_add_f32 v19, v19, v35
    v_add_f32 v20, v20, v28
    v_add_f32 v36, v36, v44
    v_add_f32 v20, v20, v36
    v_add_f32 v21, v21, v29
    v_add_f32 v37, v37, v45
    v_add_f32 v21, v21, v37
    v_add_f32 v22, v22, v30
    v_add_f32 v38, v38, v46
    v_add_f32 v22, v22, v38
    v_add_f32 v23, v23, v31
    v_add_f32 v39, v39, v47
    v_add_f32 v23, v23, v39
    v_lshlrev_b32 v40, 16, v48
    v_and_b32 v41, 0xffff0000, v48
    v_mul_f32 v40, v40, v120
    v_mul_f32 v41, v41, v120
    v_cvt_pk_bf16_f32 v42, v40, v41
    v_lshlrev_b32 v40, 16, v42
    v_and_b32 v41, 0xffff0000, v42
    v_cvt_pk_bf16_f32 v42, v16, v17
    v_lshlrev_b32 v43, 16, v42
    v_and_b32 v44, 0xffff0000, v42
    v_add_f32 v40, v40, v43
    v_add_f32 v41, v41, v44
    v_cvt_pk_bf16_f32 v52, v40, v41
    v_lshlrev_b32 v40, 16, v49
    v_and_b32 v41, 0xffff0000, v49
    v_mul_f32 v40, v40, v120
    v_mul_f32 v41, v41, v120
    v_cvt_pk_bf16_f32 v42, v40, v41
    v_lshlrev_b32 v40, 16, v42
    v_and_b32 v41, 0xffff0000, v42
    v_cvt_pk_bf16_f32 v42, v18, v19
    v_lshlrev_b32 v43, 16, v42
    v_and_b32 v44, 0xffff0000, v42
    v_add_f32 v40, v40, v43
    v_add_f32 v41, v41, v44
    v_cvt_pk_bf16_f32 v53, v40, v41
    buffer_store_dwordx2 v[52:53], v14, s[8:11], s20 offen offset:0 sc1
    v_lshlrev_b32 v40, 16, v50
    v_and_b32 v41, 0xffff0000, v50
    v_mul_f32 v40, v40, v120
    v_mul_f32 v41, v41, v120
    v_cvt_pk_bf16_f32 v42, v40, v41
    v_lshlrev_b32 v40, 16, v42
    v_and_b32 v41, 0xffff0000, v42
    v_cvt_pk_bf16_f32 v42, v20, v21
    v_lshlrev_b32 v43, 16, v42
    v_and_b32 v44, 0xffff0000, v42
    v_add_f32 v40, v40, v43
    v_add_f32 v41, v41, v44
    v_cvt_pk_bf16_f32 v54, v40, v41
    v_lshlrev_b32 v40, 16, v51
    v_and_b32 v41, 0xffff0000, v51
    v_mul_f32 v40, v40, v120
    v_mul_f32 v41, v41, v120
    v_cvt_pk_bf16_f32 v42, v40, v41
    v_lshlrev_b32 v40, 16, v42
    v_and_b32 v41, 0xffff0000, v42
    v_cvt_pk_bf16_f32 v42, v22, v23
    v_lshlrev_b32 v43, 16, v42
    v_and_b32 v44, 0xffff0000, v42
    v_add_f32 v40, v40, v43
    v_add_f32 v41, v41, v44
    v_cvt_pk_bf16_f32 v55, v40, v41
    buffer_store_dwordx2 v[54:55], v14, s[8:11], s20 offen offset:16 sc1
    v_mov_b32 v64, 0
    v_mov_b32 v65, 0
    v_mov_b32 v66, 0
    v_mov_b32 v67, 0
    v_mov_b32 v68, 0
    v_mov_b32 v69, 0
    v_mov_b32 v70, 0
    v_mov_b32 v71, 0
    v_mov_b32 v72, 0
    v_mov_b32 v73, 0
    v_mov_b32 v74, 0
    v_mov_b32 v75, 0
    v_mov_b32 v76, 0
    v_mov_b32 v77, 0
    v_mov_b32 v78, 0
    v_mov_b32 v79, 0
    v_mov_b32 v80, 0
    v_mov_b32 v81, 0
    v_mov_b32 v82, 0
    v_mov_b32 v83, 0
    v_mov_b32 v84, 0
    v_mov_b32 v85, 0
    v_mov_b32 v86, 0
    v_mov_b32 v87, 0
    v_mov_b32 v88, 0
    v_mov_b32 v89, 0
    v_mov_b32 v90, 0
    v_mov_b32 v91, 0
    v_mov_b32 v92, 0
    v_mov_b32 v93, 0
    v_mov_b32 v94, 0
    v_mov_b32 v95, 0
    s_barrier
    ds_write_b128 v1, v[124:127]
    ds_write_b128 v1, v[126:129] offset:17664
    v_alignbit_b32 v40, v125, v124, 16
    v_alignbit_b32 v44, v126, v125, 16
    v_alignbit_b32 v48, v127, v126, 16
    v_alignbit_b32 v52, v128, v127, 16
    v_mov_b32 v56, v125
    v_mov_b32 v60, v127
    v_alignbit_b32 v41, v126, v125, 16
    v_alignbit_b32 v45, v127, v126, 16
    v_alignbit_b32 v49, v128, v127, 16
    v_alignbit_b32 v53, v129, v128, 16
    v_mov_b32 v57, v126
    v_mov_b32 v61, v128
    v_alignbit_b32 v42, v127, v126, 16
    v_alignbit_b32 v46, v128, v127, 16
    v_alignbit_b32 v50, v129, v128, 16
    v_alignbit_b32 v54, v130, v129, 16
    v_mov_b32 v58, v127
    v_mov_b32 v62, v129
    v_alignbit_b32 v43, v128, v127, 16
    v_alignbit_b32 v47, v129, v128, 16
    v_alignbit_b32 v51, v130, v129, 16
    v_alignbit_b32 v55, v131, v130, 16
    v_mov_b32 v59, v128
    v_mov_b32 v63, v130
    ds_write_b128 v1, v[40:43] offset:4416
    ds_write_b128 v1, v[44:47] offset:13248
    ds_write_b128 v1, v[48:51] offset:22080
    ds_write_b128 v1, v[52:55] offset:30912
    ds_write_b128 v1, v[56:59] offset:8832
    ds_write_b128 v1, v[60:63] offset:26496
    ds_write_b128 v4, v[140:143] offset:37888
    v_cmp_gt_u32 vcc, 8, v0
    s_and_saveexec_b64 s[16:17], vcc
    ds_write_b128 v2, v[132:135]
    ds_write_b128 v2, v[134:137] offset:17664
    v_alignbit_b32 v40, v133, v132, 16
    v_alignbit_b32 v44, v134, v133, 16
    v_alignbit_b32 v48, v135, v134, 16
    v_alignbit_b32 v52, v136, v135, 16
    v_mov_b32 v56, v133
    v_mov_b32 v60, v135
    v_alignbit_b32 v41, v134, v133, 16
    v_alignbit_b32 v45, v135, v134, 16
    v_alignbit_b32 v49, v136, v135, 16
    v_alignbit_b32 v53, v137, v136, 16
    v_mov_b32 v57, v134
    v_mov_b32 v61, v136
    v_alignbit_b32 v42, v135, v134, 16
    v_alignbit_b32 v46, v136, v135, 16
    v_alignbit_b32 v50, v137, v136, 16
    v_alignbit_b32 v54, v138, v137, 16
    v_mov_b32 v58, v135
    v_mov_b32 v62, v137
    v_alignbit_b32 v43, v136, v135, 16
    v_alignbit_b32 v47, v137, v136, 16
    v_alignbit_b32 v51, v138, v137, 16
    v_alignbit_b32 v55, v139, v138, 16
    v_mov_b32 v59, v136
    v_mov_b32 v63, v138
    ds_write_b128 v2, v[40:43] offset:4416
    ds_write_b128 v2, v[44:47] offset:13248
    ds_write_b128 v2, v[48:51] offset:22080
    ds_write_b128 v2, v[52:55] offset:30912
    ds_write_b128 v2, v[56:59] offset:8832
    ds_write_b128 v2, v[60:63] offset:26496
    s_mov_b64 exec, s[16:17]
    v_lshlrev_b32 v144, 16, v144
    s_waitcnt lgkmcnt(0)
    s_barrier
C1_w0:
    s_cmp_lg_u32 s18, 0
    s_cbranch_scc1 C1_w1
    ds_read_b128 v[16:19], v8 offset:4032
    ds_read_b128 v[20:23], v9 offset:7600
    ds_read_b128 v[24:27], v9 offset:5040
    ds_read_b128 v[28:31], v8 offset:4064
    ds_read_b128 v[32:35], v9 offset:7632
    ds_read_b128 v[36:39], v9 offset:5072
    ds_read_b128 v[40:43], v8 offset:3968
    ds_read_b128 v[44:47], v9 offset:7520
    ds_read_b128 v[48:51], v9 offset:4960
    s_waitcnt lgkmcnt(6)
    v_mfma_f32_32x32x16_bf16 v[80:95], v[16:19], v[20:23], v[80:95]
    v_mfma_f32_32x32x16_bf16 v[64:79], v[16:19], v[24:27], v[64:79]
    ds_read_b128 v[52:55], v8 offset:4000
    ds_read_b128 v[56:59], v9 offset:7552
    ds_read_b128 v[60:63], v9 offset:4992
    s_waitcnt lgkmcnt(6)
    v_mfma_f32_32x32x16_bf16 v[80:95], v[28:31], v[32:35], v[80:95]
    v_mfma_f32_32x32x16_bf16 v[64:79], v[28:31], v[36:39], v[64:79]
    ds_read_b128 v[16:19], v8 offset:3904
    ds_read_b128 v[20:23], v9 offset:7440
    ds_read_b128 v[24:27], v9 offset:4880
    s_waitcnt lgkmcnt(6)
    v_mfma_f32_32x32x16_bf16 v[80:95], v[40:43], v[44:47], v[80:95]
    v_mfma_f32_32x32x16_bf16 v[64:79], v[40:43], v[48:51], v[64:79]
    ds_read_b128 v[28:31], v8 offset:3936
    ds_read_b128 v[32:35], v9 offset:7472
    ds_read_b128 v[36:39], v9 offset:4912
    s_waitcnt lgkmcnt(6)
    v_mfma_f32_32x32x16_bf16 v[80:95], v[52:55], v[56:59], v[80:95]
    v_mfma_f32_32x32x16_bf16 v[64:79], v[52:55], v[60:63], v[64:79]
    ds_read_b128 v[40:43], v8 offset:3840
    ds_read_b128 v[44:47], v9 offset:7360
    ds_read_b128 v[48:51], v9 offset:4800
    s_waitcnt lgkmcnt(6)
    v_mfma_f32_32x32x16_bf16 v[80:95], v[16:19], v[20:23], v[80:95]
    v_mfma_f32_32x32x16_bf16 v[64:79], v[16:19], v[24:27], v[64:79]
    ds_read_b128 v[52:55], v8 offset:3872
    ds_read_b128 v[56:59], v9 offset:7392
    ds_read_b128 v[60:63], v9 offset:4832
    s_waitcnt lgkmcnt(6)
    v_mfma_f32_32x32x16_bf16 v[80:95], v[28:31], v[32:35], v[80:95]
    v_mfma_f32_32x32x16_bf16 v[64:79], v[28:31], v[36:39], v[64:79]
    ds_read_b128 v[16:19], v8 offset:3776
    ds_read_b128 v[20:23], v9 offset:7280
    ds_read_b128 v[24:27], v9 offset:4720
    s_waitcnt lgkmcnt(6)
    v_mfma_f32_32x32x16_bf16 v[80:95], v[40:43], v[44:47], v[80:95]
    v_mfma_f32_32x32x16_bf16 v[64:79], v[40:43], v[48:51], v[64:79]
    ds_read_b128 v[28:31], v8 offset:3808
    ds_read_b128 v[32:35], v9 offset:7312
    ds_read_b128 v[36:39], v9 offset:4752
    s_waitcnt lgkmcnt(6)
    v_mfma_f32_32x32x16_bf16 v[80:95], v[52:55], v[56:59], v[80:95]
    v_mfma_f32_32x32x16_bf16 v[64:79], v[52:55], v[60:63], v[64:79]
    ds_read_b128 v[40:43], v8 offset:3712
    ds_read_b128 v[44:47], v9 offset:7200
    ds_read_b128 v[48:51], v9 offset:4640
    s_waitcnt lgkmcnt(6)
    v_mfma_f32_32x32x16_bf16 v[80:95], v[16:19], v[20:23], v[80:95]
    v_mfma_f32_32x32x16_bf16 v[64:79], v[16:19], v[24:27], v[64:79]
    ds_read_b128 v[52:55], v8 offset:3744
    ds_read_b128 v[56:59], v9 offset:7232
    ds_read_b128 v[60:63], v9 offset:4672
    s_waitcnt lgkmcnt(6)
    v_mfma_f32_32x32x16_bf16 v[80:95], v[28:31], v[32:35], v[80:95]
    v_mfma_f32_32x32x16_bf16 v[64:79], v[28:31], v[36:39], v[64:79]
    ds_read_b128 v[16:19], v8 offset:3648
    ds_read_b128 v[20:23], v9 offset:7120
    ds_read_b128 v[24:27], v9 offset:4560
    s_waitcnt lgkmcnt(6)
    v_mfma_f32_32x32x16_bf16 v[80:95], v[40:43], v[44:47], v[80:95]
    v_mfma_f32_32x32x16_bf16 v[64:79], v[40:43], v[48:51], v[64:79]
    ds_read_b128 v[28:31], v8 offset:3680
    ds_read_b128 v[32:35], v9 offset:7152
    ds_read_b128 v[36:39], v9 offset:4592
    s_waitcnt lgkmcnt(6)
    v_mfma_f32_32x32x16_bf16 v[80:95], v[52:55], v[56:59], v[80:95]
    v_mfma_f32_32x32x16_bf16 v[64:79], v[52:55], v[60:63], v[64:79]
    ds_read_b128 v[40:43], v8 offset:3584
    ds_read_b128 v[44:47], v9 offset:7040
    ds_read_b128 v[48:51], v9 offset:4480
    s_waitcnt lgkmcnt(6)
    v_mfma_f32_32x32x16_bf16 v[80:95], v[16:19], v[20:23], v[80:95]
    v_mfma_f32_32x32x16_bf16 v[64:79], v[16:19], v[24:27], v[64:79]
    ds_read_b128 v[52:55], v8 offset:3616
    ds_read_b128 v[56:59], v9 offset:7072
    ds_read_b128 v[60:63], v9 offset:4512
    s_waitcnt lgkmcnt(6)
    v_mfma_f32_32x32x16_bf16 v[80:95], v[28:31], v[32:35], v[80:95]
    v_mfma_f32_32x32x16_bf16 v[64:79], v[28:31], v[36:39], v[64:79]
    ds_read_b128 v[16:19], v8 offset:3520
    ds_read_b128 v[20:23], v9 offset:6960
    ds_read_b128 v[24:27], v9 offset:4400
    s_waitcnt lgkmcnt(6)
    v_mfma_f32_32x32x16_bf16 v[80:95], v[40:43], v[44:47], v[80:95]
    v_mfma_f32_32x32x16_bf16 v[64:79], v[40:43], v[48:51], v[64:79]
    ds_read_b128 v[28:31], v8 offset:3552
    ds_read_b128 v[32:35], v9 offset:6992
    ds_read_b128 v[36:39], v9 offset:4432
    s_waitcnt lgkmcnt(6)
    v_mfma_f32_32x32x16_bf16 v[80:95], v[52:55], v[56:59], v[80:95]
    v_mfma_f32_32x32x16_bf16 v[64:79], v[52:55], v[60:63], v[64:79]
    ds_read_b128 v[40:43], v8 offset:3456
    ds_read_b128 v[44:47], v9 offset:6880
    ds_read_b128 v[48:51], v9 offset:4320
    s_waitcnt lgkmcnt(6)
    v_mfma_f32_32x32x16_bf16 v[80:95], v[16:19], v[20:23], v[80:95]
    v_mfma_f32_32x32x16_bf16 v[64:79], v[16:19], v[24:27], v[64:79]
    ds_read_b128 v[52:55], v8 offset:3488
    ds_read_b128 v[56:59], v9 offset:6912
    ds_read_b128 v[60:63], v9 offset:4352
    s_waitcnt lgkmcnt(6)
    v_mfma_f32_32x32x16_bf16 v[80:95], v[28:31], v[32:35], v[80:95]
    v_mfma_f32_32x32x16_bf16 v[64:79], v[28:31], v[36:39], v[64:79]
    ds_read_b128 v[16:19], v8 offset:3392
    ds_read_b128 v[20:23], v9 offset:6800
    ds_read_b128 v[24:27], v9 offset:4240
    s_waitcnt lgkmcnt(6)
    v_mfma_f32_32x32x16_bf16 v[80:95], v[40:43], v[44:47], v[80:95]
    v_mfma_f32_32x32x16_bf16 v[64:79], v[40:43], v[48:51], v[64:79]
    ds_read_b128 v[28:31], v8 offset:3424
    ds_read_b128 v[32:35], v9 offset:6832
    ds_read_b128 v[36:39], v9 offset:4272
    s_waitcnt lgkmcnt(6)
    v_mfma_f32_32x32x16_bf16 v[80:95], v[52:55], v[56:59], v[80:95]
    v_mfma_f32_32x32x16_bf16 v[64:79], v[52:55], v[60:63], v[64:79]
    ds_read_b128 v[40:43], v8 offset:3328
    ds_read_b128 v[44:47], v9 offset:6720
    ds_read_b128 v[48:51], v9 offset:4160
    s_waitcnt lgkmcnt(6)
    v_mfma_f32_32x32x16_bf16 v[80:95], v[16:19], v[20:23], v[80:95]
    v_mfma_f32_32x32x16_bf16 v[64:79], v[16:19], v[24:27], v[64:79]
    ds_read_b128 v[52:55], v8 offset:3360
    ds_read_b128 v[56:59], v9 offset:6752
    ds_read_b128 v[60:63], v9 offset:4192
    s_waitcnt lgkmcnt(6)
    v_mfma_f32_32x32x16_bf16 v[80:95], v[28:31], v[32:35], v[80:95]
    v_mfma_f32_32x32x16_bf16 v[64:79], v[28:31], v[36:39], v[64:79]
    s_waitcnt lgkmcnt(3)
    v_mfma_f32_32x32x16_bf16 v[80:95], v[40:43], v[44:47], v[80:95]
    v_mfma_f32_32x32x16_bf16 v[64:79], v[40:43], v[48:51], v[64:79]
    s_waitcnt lgkmcnt(0)
    v_mfma_f32_32x32x16_bf16 v[80:95], v[52:55], v[56:59], v[80:95]
    v_mfma_f32_32x32x16_bf16 v[64:79], v[52:55], v[60:63], v[64:79]
    s_branch C1_red
C1_w1:
    s_cmp_lg_u32 s18, 1
    s_cbranch_scc1 C1_w2
    ds_read_b128 v[16:19], v8 offset:3264
    ds_read_b128 v[20:23], v9 offset:6640
    ds_read_b128 v[24:27], v9 offset:4080
    ds_read_b128 v[28:31], v8 offset:3296
    ds_read_b128 v[32:35], v9 offset:6672
    ds_read_b128 v[36:39], v9 offset:4112
    ds_read_b128 v[40:43], v8 offset:3200
    ds_read_b128 v[44:47], v9 offset:6560
    ds_read_b128 v[48:51], v9 offset:4000
    s_waitcnt lgkmcnt(6)
    v_mfma_f32_32x32x16_bf16 v[80:95], v[16:19], v[20:23], v[80:95]
    v_mfma_f32_32x32x16_bf16 v[64:79], v[16:19], v[24:27], v[64:79]
    ds_read_b128 v[52:55], v8 offset:3232
    ds_read_b128 v[56:59], v9 offset:6592
    ds_read_b128 v[60:63], v9 offset:4032
    s_waitcnt lgkmcnt(6)
    v_mfma_f32_32x32x16_bf16 v[80:95], v[28:31], v[32:35], v[80:95]
    v_mfma_f32_32x32x16_bf16 v[64:79], v[28:31], v[36:39], v[64:79]
    ds_read_b128 v[16:19], v8 offset:3136
    ds_read_b128 v[20:23], v9 offset:6480
    ds_read_b128 v[24:27], v9 offset:3920
    s_waitcnt lgkmcnt(6)
    v_mfma_f32_32x32x16_bf16 v[80:95], v[40:43], v[44:47], v[80:95]
    v_mfma_f32_32x32x16_bf16 v[64:79], v[40:43], v[48:51], v[64:79]
    ds_read_b128 v[28:31], v8 offset:3168
    ds_read_b128 v[32:35], v9 offset:6512
    ds_read_b128 v[36:39], v9 offset:3952
    s_waitcnt lgkmcnt(6)
    v_mfma_f32_32x32x16_bf16 v[80:95], v[52:55], v[56:59], v[80:95]
    v_mfma_f32_32x32x16_bf16 v[64:79], v[52:55], v[60:63], v[64:79]
    ds_read_b128 v[40:43], v8 offset:3072
    ds_read_b128 v[44:47], v9 offset:6400
    ds_read_b128 v[48:51], v9 offset:3840
    s_waitcnt lgkmcnt(6)
    v_mfma_f32_32x32x16_bf16 v[80:95], v[16:19], v[20:23], v[80:95]
    v_mfma_f32_32x32x16_bf16 v[64:79], v[16:19], v[24:27], v[64:79]
    ds_read_b128 v[52:55], v8 offset:3104
    ds_read_b128 v[56:59], v9 offset:6432
    ds_read_b128 v[60:63], v9 offset:3872
    s_waitcnt lgkmcnt(6)
    v_mfma_f32_32x32x16_bf16 v[80:95], v[28:31], v[32:35], v[80:95]
    v_mfma_f32_32x32x16_bf16 v[64:79], v[28:31], v[36:39], v[64:79]
    ds_read_b128 v[16:19], v8 offset:3008
    ds_read_b128 v[20:23], v9 offset:6320
    ds_read_b128 v[24:27], v9 offset:3760
    s_waitcnt lgkmcnt(6)
    v_mfma_f32_32x32x16_bf16 v[80:95], v[40:43], v[44:47], v[80:95]
    v_mfma_f32_32x32x16_bf16 v[64:79], v[40:43], v[48:51], v[64:79]
    ds_read_b128 v[28:31], v8 offset:3040
    ds_read_b128 v[32:35], v9 offset:6352
    ds_read_b128 v[36:39], v9 offset:3792
    s_waitcnt lgkmcnt(6)
    v_mfma_f32_32x32x16_bf16 v[80:95], v[52:55], v[56:59], v[80:95]
    v_mfma_f32_32x32x16_bf16 v[64:79], v[52:55], v[60:63], v[64:79]
    ds_read_b128 v[40:43], v8 offset:2944
    ds_read_b128 v[44:47], v9 offset:6240
    ds_read_b128 v[48:51], v9 offset:3680
    s_waitcnt lgkmcnt(6)
    v_mfma_f32_32x32x16_bf16 v[80:95], v[16:19], v[20:23], v[80:95]
    v_mfma_f32_32x32x16_bf16 v[64:79], v[16:19], v[24:27], v[64:79]
    ds_read_b128 v[52:55], v8 offset:2976
    ds_read_b128 v[56:59], v9 offset:6272
    ds_read_b128 v[60:63], v9 offset:3712
    s_waitcnt lgkmcnt(6)
    v_mfma_f32_32x32x16_bf16 v[80:95], v[28:31], v[32:35], v[80:95]
    v_mfma_f32_32x32x16_bf16 v[64:79], v[28:31], v[36:39], v[64:79]
    ds_read_b128 v[16:19], v8 offset:2880
    ds_read_b128 v[20:23], v9 offset:6160
    ds_read_b128 v[24:27], v9 offset:3600
    s_waitcnt lgkmcnt(6)
    v_mfma_f32_32x32x16_bf16 v[80:95], v[40:43], v[44:47], v[80:95]
    v_mfma_f32_32x32x16_bf16 v[64:79], v[40:43], v[48:51], v[64:79]
    ds_read_b128 v[28:31], v8 offset:2912
    ds_read_b128 v[32:35], v9 offset:6192
    ds_read_b128 v[36:39], v9 offset:3632
    s_waitcnt lgkmcnt(6)
    v_mfma_f32_32x32x16_bf16 v[80:95], v[52:55], v[56:59], v[80:95]
    v_mfma_f32_32x32x16_bf16 v[64:79], v[52:55], v[60:63], v[64:79]
    ds_read_b128 v[40:43], v8 offset:2816
    ds_read_b128 v[44:47], v9 offset:6080
    ds_read_b128 v[48:51], v9 offset:3520
    s_waitcnt lgkmcnt(6)
    v_mfma_f32_32x32x16_bf16 v[80:95], v[16:19], v[20:23], v[80:95]
    v_mfma_f32_32x32x16_bf16 v[64:79], v[16:19], v[24:27], v[64:79]
    ds_read_b128 v[52:55], v8 offset:2848
    ds_read_b128 v[56:59], v9 offset:6112
    ds_read_b128 v[60:63], v9 offset:3552
    s_waitcnt lgkmcnt(6)
    v_mfma_f32_32x32x16_bf16 v[80:95], v[28:31], v[32:35], v[80:95]
    v_mfma_f32_32x32x16_bf16 v[64:79], v[28:31], v[36:39], v[64:79]
    ds_read_b128 v[16:19], v8 offset:2752
    ds_read_b128 v[20:23], v9 offset:6000
    ds_read_b128 v[24:27], v9 offset:3440
    s_waitcnt lgkmcnt(6)
    v_mfma_f32_32x32x16_bf16 v[80:95], v[40:43], v[44:47], v[80:95]
    v_mfma_f32_32x32x16_bf16 v[64:79], v[40:43], v[48:51], v[64:79]
    ds_read_b128 v[28:31], v8 offset:2784
    ds_read_b128 v[32:35], v9 offset:6032
    ds_read_b128 v[36:39], v9 offset:3472
    s_waitcnt lgkmcnt(6)
    v_mfma_f32_32x32x16_bf16 v[80:95], v[52:55], v[56:59], v[80:95]
    v_mfma_f32_32x32x16_bf16 v[64:79], v[52:55], v[60:63], v[64:79]
    ds_read_b128 v[40:43], v8 offset:2688
    ds_read_b128 v[44:47], v9 offset:5920
    ds_read_b128 v[48:51], v9 offset:3360
    s_waitcnt lgkmcnt(6)
    v_mfma_f32_32x32x16_bf16 v[80:95], v[16:19], v[20:23], v[80:95]
    v_mfma_f32_32x32x16_bf16 v[64:79], v[16:19], v[24:27], v[64:79]
    ds_read_b128 v[52:55], v8 offset:2720
    ds_read_b128 v[56:59], v9 offset:5952
    ds_read_b128 v[60:63], v9 offset:3392
    s_waitcnt lgkmcnt(6)
    v_mfma_f32_32x32x16_bf16 v[80:95], v[28:31], v[32:35], v[80:95]
    v_mfma_f32_32x32x16_bf16 v[64:79], v[28:31], v[36:39], v[64:79]
    ds_read_b128 v[16:19], v8 offset:2624
    ds_read_b128 v[20:23], v9 offset:5840
    ds_read_b128 v[24:27], v9 offset:3280
    s_waitcnt lgkmcnt(6)
    v_mfma_f32_32x32x16_bf16 v[80:95], v[40:43], v[44:47], v[80:95]
    v_mfma_f32_32x32x16_bf16 v[64:79], v[40:43], v[48:51], v[64:79]
    ds_read_b128 v[28:31], v8 offset:2656
    ds_read_b128 v[32:35], v9 offset:5872
    ds_read_b128 v[36:39], v9 offset:3312
    s_waitcnt lgkmcnt(6)
    v_mfma_f32_32x32x16_bf16 v[80:95], v[52:55], v[56:59], v[80:95]
    v_mfma_f32_32x32x16_bf16 v[64:79], v[52:55], v[60:63], v[64:79]
    ds_read_b128 v[40:43], v8 offset:2560
    ds_read_b128 v[44:47], v9 offset:5760
    ds_read_b128 v[48:51], v9 offset:3200
    s_waitcnt lgkmcnt(6)
    v_mfma_f32_32x32x16_bf16 v[80:95], v[16:19], v[20:23], v[80:95]
    v_mfma_f32_32x32x16_bf16 v[64:79], v[16:19], v[24:27], v[64:79]
    ds_read_b128 v[52:55], v8 offset:2592
    ds_read_b128 v[56:59], v9 offset:5792
    ds_read_b128 v[60:63], v9 offset:3232
    s_waitcnt lgkmcnt(6)
    v_mfma_f32_32x32x16_bf16 v[80:95], v[28:31], v[32:35], v[80:95]
    v_mfma_f32_32x32x16_bf16 v[64:79], v[28:31], v[36:39], v[64:79]
    s_waitcnt lgkmcnt(3)
    v_mfma_f32_32x32x16_bf16 v[80:95], v[40:43], v[44:47], v[80:95]
    v_mfma_f32_32x32x16_bf16 v[64:79], v[40:43], v[48:51], v[64:79]
    s_waitcnt lgkmcnt(0)
    v_mfma_f32_32x32x16_bf16 v[80:95], v[52:55], v[56:59], v[80:95]
    v_mfma_f32_32x32x16_bf16 v[64:79], v[52:55], v[60:63], v[64:79]
    s_branch C1_red
C1_w2:
    s_cmp_lg_u32 s18, 2
    s_cbranch_scc1 C1_w3
    ds_read_b128 v[16:19], v8 offset:2496
    ds_read_b128 v[20:23], v9 offset:5680
    ds_read_b128 v[24:27], v9 offset:3120
    ds_read_b128 v[28:31], v8 offset:2528
    ds_read_b128 v[32:35], v9 offset:5712
    ds_read_b128 v[36:39], v9 offset:3152
    ds_read_b128 v[40:43], v8 offset:2432
    ds_read_b128 v[44:47], v9 offset:5600
    ds_read_b128 v[48:51], v9 offset:3040
    s_waitcnt lgkmcnt(6)
    v_mfma_f32_32x32x16_bf16 v[80:95], v[16:19], v[20:23], v[80:95]
    v_mfma_f32_32x32x16_bf16 v[64:79], v[16:19], v[24:27], v[64:79]
    ds_read_b128 v[52:55], v8 offset:2464
    ds_read_b128 v[56:59], v9 offset:5632
    ds_read_b128 v[60:63], v9 offset:3072
    s_waitcnt lgkmcnt(6)
    v_mfma_f32_32x32x16_bf16 v[80:95], v[28:31], v[32:35], v[80:95]
    v_mfma_f32_32x32x16_bf16 v[64:79], v[28:31], v[36:39], v[64:79]
    ds_read_b128 v[16:19], v8 offset:2368
    ds_read_b128 v[20:23], v9 offset:5520
    ds_read_b128 v[24:27], v9 offset:2960
    s_waitcnt lgkmcnt(6)
    v_mfma_f32_32x32x16_bf16 v[80:95], v[40:43], v[44:47], v[80:95]
    v_mfma_f32_32x32x16_bf16 v[64:79], v[40:43], v[48:51], v[64:79]
    ds_read_b128 v[28:31], v8 offset:2400
    ds_read_b128 v[32:35], v9 offset:5552
    ds_read_b128 v[36:39], v9 offset:2992
    s_waitcnt lgkmcnt(6)
    v_mfma_f32_32x32x16_bf16 v[80:95], v[52:55], v[56:59], v[80:95]
    v_mfma_f32_32x32x16_bf16 v[64:79], v[52:55], v[60:63], v[64:79]
    ds_read_b128 v[40:43], v8 offset:2304
    ds_read_b128 v[44:47], v9 offset:5440
    ds_read_b128 v[48:51], v9 offset:2880
    s_waitcnt lgkmcnt(6)
    v_mfma_f32_32x32x16_bf16 v[80:95], v[16:19], v[20:23], v[80:95]
    v_mfma_f32_32x32x16_bf16 v[64:79], v[16:19], v[24:27], v[64:79]
    ds_read_b128 v[52:55], v8 offset:2336
    ds_read_b128 v[56:59], v9 offset:5472
    ds_read_b128 v[60:63], v9 offset:2912
    s_waitcnt lgkmcnt(6)
    v_mfma_f32_32x32x16_bf16 v[80:95], v[28:31], v[32:35], v[80:95]
    v_mfma_f32_32x32x16_bf16 v[64:79], v[28:31], v[36:39], v[64:79]
    ds_read_b128 v[16:19], v8 offset:2240
    ds_read_b128 v[20:23], v9 offset:5360
    ds_read_b128 v[24:27], v9 offset:2800
    s_waitcnt lgkmcnt(6)
    v_mfma_f32_32x32x16_bf16 v[80:95], v[40:43], v[44:47], v[80:95]
    v_mfma_f32_32x32x16_bf16 v[64:79], v[40:43], v[48:51], v[64:79]
    ds_read_b128 v[28:31], v8 offset:2272
    ds_read_b128 v[32:35], v9 offset:5392
    ds_read_b128 v[36:39], v9 offset:2832
    s_waitcnt lgkmcnt(6)
    v_mfma_f32_32x32x16_bf16 v[80:95], v[52:55], v[56:59], v[80:95]
    v_mfma_f32_32x32x16_bf16 v[64:79], v[52:55], v[60:63], v[64:79]
    ds_read_b128 v[40:43], v8 offset:2176
    ds_read_b128 v[44:47], v9 offset:5280
    ds_read_b128 v[48:51], v9 offset:2720
    s_waitcnt lgkmcnt(6)
    v_mfma_f32_32x32x16_bf16 v[80:95], v[16:19], v[20:23], v[80:95]
    v_mfma_f32_32x32x16_bf16 v[64:79], v[16:19], v[24:27], v[64:79]
    ds_read_b128 v[52:55], v8 offset:2208
    ds_read_b128 v[56:59], v9 offset:5312
    ds_read_b128 v[60:63], v9 offset:2752
    s_waitcnt lgkmcnt(6)
    v_mfma_f32_32x32x16_bf16 v[80:95], v[28:31], v[32:35], v[80:95]
    v_mfma_f32_32x32x16_bf16 v[64:79], v[28:31], v[36:39], v[64:79]
    ds_read_b128 v[16:19], v8 offset:2112
    ds_read_b128 v[20:23], v9 offset:5200
    ds_read_b128 v[24:27], v9 offset:2640
    s_waitcnt lgkmcnt(6)
    v_mfma_f32_32x32x16_bf16 v[80:95], v[40:43], v[44:47], v[80:95]
    v_mfma_f32_32x32x16_bf16 v[64:79], v[40:43], v[48:51], v[64:79]
    ds_read_b128 v[28:31], v8 offset:2144
    ds_read_b128 v[32:35], v9 offset:5232
    ds_read_b128 v[36:39], v9 offset:2672
    s_waitcnt lgkmcnt(6)
    v_mfma_f32_32x32x16_bf16 v[80:95], v[52:55], v[56:59], v[80:95]
    v_mfma_f32_32x32x16_bf16 v[64:79], v[52:55], v[60:63], v[64:79]
    ds_read_b128 v[40:43], v8 offset:2048
    ds_read_b128 v[44:47], v9 offset:5120
    ds_read_b128 v[48:51], v9 offset:2560
    s_waitcnt lgkmcnt(6)
    v_mfma_f32_32x32x16_bf16 v[80:95], v[16:19], v[20:23], v[80:95]
    v_mfma_f32_32x32x16_bf16 v[64:79], v[16:19], v[24:27], v[64:79]
    ds_read_b128 v[52:55], v8 offset:2080
    ds_read_b128 v[56:59], v9 offset:5152
    ds_read_b128 v[60:63], v9 offset:2592
    s_waitcnt lgkmcnt(6)
    v_mfma_f32_32x32x16_bf16 v[80:95], v[28:31], v[32:35], v[80:95]
    v_mfma_f32_32x32x16_bf16 v[64:79], v[28:31], v[36:39], v[64:79]
    ds_read_b128 v[16:19], v8 offset:1984
    ds_read_b128 v[20:23], v9 offset:5040
    s_waitcnt lgkmcnt(5)
    v_mfma_f32_32x32x16_bf16 v[80:95], v[40:43], v[44:47], v[80:95]
    v_mfma_f32_32x32x16_bf16 v[64:79], v[40:43], v[48:51], v[64:79]
    ds_read_b128 v[28:31], v8 offset:2016
    ds_read_b128 v[32:35], v9 offset:5072
    s_waitcnt lgkmcnt(4)
    v_mfma_f32_32x32x16_bf16 v[80:95], v[52:55], v[56:59], v[80:95]
    v_mfma_f32_32x32x16_bf16 v[64:79], v[52:55], v[60:63], v[64:79]
    ds_read_b128 v[40:43], v8 offset:1920
    ds_read_b128 v[44:47], v9 offset:4960
    s_waitcnt lgkmcnt(4)
    v_mfma_f32_32x32x16_bf16 v[80:95], v[16:19], v[20:23], v[80:95]
    ds_read_b128 v[52:55], v8 offset:1952
    ds_read_b128 v[56:59], v9 offset:4992
    s_waitcnt lgkmcnt(4)
    v_mfma_f32_32x32x16_bf16 v[80:95], v[28:31], v[32:35], v[80:95]
    ds_read_b128 v[16:19], v8 offset:1856
    ds_read_b128 v[20:23], v9 offset:4880
    s_waitcnt lgkmcnt(4)
    v_mfma_f32_32x32x16_bf16 v[80:95], v[40:43], v[44:47], v[80:95]
    ds_read_b128 v[28:31], v8 offset:1888
    ds_read_b128 v[32:35], v9 offset:4912
    s_waitcnt lgkmcnt(4)
    v_mfma_f32_32x32x16_bf16 v[80:95], v[52:55], v[56:59], v[80:95]
    ds_read_b128 v[40:43], v8 offset:1792
    ds_read_b128 v[44:47], v9 offset:4800
    s_waitcnt lgkmcnt(4)
    v_mfma_f32_32x32x16_bf16 v[80:95], v[16:19], v[20:23], v[80:95]
    ds_read_b128 v[52:55], v8 offset:1824
    ds_read_b128 v[56:59], v9 offset:4832
    s_waitcnt lgkmcnt(4)
    v_mfma_f32_32x32x16_bf16 v[80:95], v[28:31], v[32:35], v[80:95]
    ds_read_b128 v[16:19], v8 offset:1728
    ds_read_b128 v[20:23], v9 offset:4720
    s_waitcnt lgkmcnt(4)
    v_mfma_f32_32x32x16_bf16 v[80:95], v[40:43], v[44:47], v[80:95]
    ds_read_b128 v[28:31], v8 offset:1760
    ds_read_b128 v[32:35], v9 offset:4752
    s_waitcnt lgkmcnt(4)
    v_mfma_f32_32x32x16_bf16 v[80:95], v[52:55], v[56:59], v[80:95]
    ds_read_b128 v[40:43], v8 offset:1664
    ds_read_b128 v[44:47], v9 offset:4640
    s_waitcnt lgkmcnt(4)
    v_mfma_f32_32x32x16_bf16 v[80:95], v[16:19], v[20:23], v[80:95]
    ds_read_b128 v[52:55], v8 offset:1696
    ds_read_b128 v[56:59], v9 offset:4672
    s_waitcnt lgkmcnt(4)
    v_mfma_f32_32x32x16_bf16 v[80:95], v[28:31], v[32:35], v[80:95]
    ds_read_b128 v[16:19], v8 offset:1600
    ds_read_b128 v[20:23], v9 offset:4560
    s_waitcnt lgkmcnt(4)
    v_mfma_f32_32x32x16_bf16 v[80:95], v[40:43], v[44:47], v[80:95]
    ds_read_b128 v[28:31], v8 offset:1632
    ds_read_b128 v[32:35], v9 offset:4592
    s_waitcnt lgkmcnt(4)
    v_mfma_f32_32x32x16_bf16 v[80:95], v[52:55], v[56:59], v[80:95]
    ds_read_b128 v[40:43], v8 offset:1536
    ds_read_b128 v[44:47], v9 offset:4480
    s_waitcnt lgkmcnt(4)
    v_mfma_f32_32x32x16_bf16 v[80:95], v[16:19], v[20:23], v[80:95]
    ds_read_b128 v[52:55], v8 offset:1568
    ds_read_b128 v[56:59], v9 offset:4512
    s_waitcnt lgkmcnt(4)
    v_mfma_f32_32x32x16_bf16 v[80:95], v[28:31], v[32:35], v[80:95]
    s_waitcnt lgkmcnt(2)
    v_mfma_f32_32x32x16_bf16 v[80:95], v[40:43], v[44:47], v[80:95]
    s_waitcnt lgkmcnt(0)
    v_mfma_f32_32x32x16_bf16 v[80:95], v[52:55], v[56:59], v[80:95]
    s_branch C1_red
C1_w3:
    ds_read_b128 v[16:19], v8 offset:1472
    ds_read_b128 v[20:23], v9 offset:4400
    ds_read_b128 v[28:31], v8 offset:1504
    ds_read_b128 v[32:35], v9 offset:4432
    ds_read_b128 v[40:43], v8 offset:1408
    ds_read_b128 v[44:47], v9 offset:4320
    s_waitcnt lgkmcnt(4)
    v_mfma_f32_32x32x16_bf16 v[80:95], v[16:19], v[20:23], v[80:95]
    ds_read_b128 v[52:55], v8 offset:1440
    ds_read_b128 v[56:59], v9 offset:4352
    s_waitcnt lgkmcnt(4)
    v_mfma_f32_32x32x16_bf16 v[80:95], v[28:31], v[32:35], v[80:95]
    ds_read_b128 v[16:19], v8 offset:1344
    ds_read_b128 v[20:23], v9 offset:4240
    s_waitcnt lgkmcnt(4)
    v_mfma_f32_32x32x16_bf16 v[80:95], v[40:43], v[44:47], v[80:95]
    ds_read_b128 v[28:31], v8 offset:1376
    ds_read_b128 v[32:35], v9 offset:4272
    s_waitcnt lgkmcnt(4)
    v_mfma_f32_32x32x16_bf16 v[80:95], v[52:55], v[56:59], v[80:95]
    ds_read_b128 v[40:43], v8 offset:1280
    ds_read_b128 v[44:47], v9 offset:4160
    s_waitcnt lgkmcnt(4)
    v_mfma_f32_32x32x16_bf16 v[80:95], v[16:19], v[20:23], v[80:95]
    ds_read_b128 v[52:55], v8 offset:1312
    ds_read_b128 v[56:59], v9 offset:4192
    s_waitcnt lgkmcnt(4)
    v_mfma_f32_32x32x16_bf16 v[80:95], v[28:31], v[32:35], v[80:95]
    ds_read_b128 v[16:19], v8 offset:1216
    ds_read_b128 v[20:23], v9 offset:4080
    s_waitcnt lgkmcnt(4)
    v_mfma_f32_32x32x16_bf16 v[80:95], v[40:43], v[44:47], v[80:95]
    ds_read_b128 v[28:31], v8 offset:1248
    ds_read_b128 v[32:35], v9 offset:4112
    s_waitcnt lgkmcnt(4)
    v_mfma_f32_32x32x16_bf16 v[80:95], v[52:55], v[56:59], v[80:95]
    ds_read_b128 v[40:43], v8 offset:1152
    ds_read_b128 v[44:47], v9 offset:4000
    s_waitcnt lgkmcnt(4)
    v_mfma_f32_32x32x16_bf16 v[80:95], v[16:19], v[20:23], v[80:95]
    ds_read_b128 v[52:55], v8 offset:1184
    ds_read_b128 v[56:59], v9 offset:4032
    s_waitcnt lgkmcnt(4)
    v_mfma_f32_32x32x16_bf16 v[80:95], v[28:31], v[32:35], v[80:95]
    ds_read_b128 v[16:19], v8 offset:1088
    ds_read_b128 v[20:23], v9 offset:3920
    s_waitcnt lgkmcnt(4)
    v_mfma_f32_32x32x16_bf16 v[80:95], v[40:43], v[44:47], v[80:95]
    ds_read_b128 v[28:31], v8 offset:1120
    ds_read_b128 v[32:35], v9 offset:3952
    s_waitcnt lgkmcnt(4)
    v_mfma_f32_32x32x16_bf16 v[80:95], v[52:55], v[56:59], v[80:95]
    ds_read_b128 v[40:43], v8 offset:1024
    ds_read_b128 v[44:47], v9 offset:3840
    s_waitcnt lgkmcnt(4)
    v_mfma_f32_32x32x16_bf16 v[80:95], v[16:19], v[20:23], v[80:95]
    ds_read_b128 v[52:55], v8 offset:1056
    ds_read_b128 v[56:59], v9 offset:3872
    s_waitcnt lgkmcnt(4)
    v_mfma_f32_32x32x16_bf16 v[80:95], v[28:31], v[32:35], v[80:95]
    ds_read_b128 v[16:19], v8 offset:960
    ds_read_b128 v[20:23], v9 offset:3760
    s_waitcnt lgkmcnt(4)
    v_mfma_f32_32x32x16_bf16 v[80:95], v[40:43], v[44:47], v[80:95]
    ds_read_b128 v[28:31], v8 offset:992
    ds_read_b128 v[32:35], v9 offset:3792
    s_waitcnt lgkmcnt(4)
    v_mfma_f32_32x32x16_bf16 v[80:95], v[52:55], v[56:59], v[80:95]
    ds_read_b128 v[40:43], v8 offset:896
    ds_read_b128 v[44:47], v9 offset:3680
    s_waitcnt lgkmcnt(4)
    v_mfma_f32_32x32x16_bf16 v[80:95], v[16:19], v[20:23], v[80:95]
    ds_read_b128 v[52:55], v8 offset:928
    ds_read_b128 v[56:59], v9 offset:3712
    s_waitcnt lgkmcnt(4)
    v_mfma_f32_32x32x16_bf16 v[80:95], v[28:31], v[32:35], v[80:95]
    ds_read_b128 v[16:19], v8 offset:832
    ds_read_b128 v[20:23], v9 offset:3600
    s_waitcnt lgkmcnt(4)
    v_mfma_f32_32x32x16_bf16 v[80:95], v[40:43], v[44:47], v[80:95]
    ds_read_b128 v[28:31], v8 offset:864
    ds_read_b128 v[32:35], v9 offset:3632
    s_waitcnt lgkmcnt(4)
    v_mfma_f32_32x32x16_bf16 v[80:95], v[52:55], v[56:59], v[80:95]
    ds_read_b128 v[40:43], v8 offset:768
    ds_read_b128 v[44:47], v9 offset:3520
    s_waitcnt lgkmcnt(4)
    v_mfma_f32_32x32x16_bf16 v[80:95], v[16:19], v[20:23], v[80:95]
    ds_read_b128 v[52:55], v8 offset:800
    ds_read_b128 v[56:59], v9 offset:3552
    s_waitcnt lgkmcnt(4)
    v_mfma_f32_32x32x16_bf16 v[80:95], v[28:31], v[32:35], v[80:95]
    ds_read_b128 v[16:19], v8 offset:704
    ds_read_b128 v[20:23], v9 offset:3440
    s_waitcnt lgkmcnt(4)
    v_mfma_f32_32x32x16_bf16 v[80:95], v[40:43], v[44:47], v[80:95]
    ds_read_b128 v[28:31], v8 offset:736
    ds_read_b128 v[32:35], v9 offset:3472
    s_waitcnt lgkmcnt(4)
    v_mfma_f32_32x32x16_bf16 v[80:95], v[52:55], v[56:59], v[80:95]
    ds_read_b128 v[40:43], v8 offset:640
    ds_read_b128 v[44:47], v9 offset:3360
    s_waitcnt lgkmcnt(4)
    v_mfma_f32_32x32x16_bf16 v[80:95], v[16:19], v[20:23], v[80:95]
    ds_read_b128 v[52:55], v8 offset:672
    ds_read_b128 v[56:59], v9 offset:3392
    s_waitcnt lgkmcnt(4)
    v_mfma_f32_32x32x16_bf16 v[80:95], v[28:31], v[32:35], v[80:95]
    ds_read_b128 v[16:19], v8 offset:576
    ds_read_b128 v[20:23], v9 offset:3280
    s_waitcnt lgkmcnt(4)
    v_mfma_f32_32x32x16_bf16 v[80:95], v[40:43], v[44:47], v[80:95]
    ds_read_b128 v[28:31], v8 offset:608
    ds_read_b128 v[32:35], v9 offset:3312
    s_waitcnt lgkmcnt(4)
    v_mfma_f32_32x32x16_bf16 v[80:95], v[52:55], v[56:59], v[80:95]
    ds_read_b128 v[40:43], v8 offset:512
    ds_read_b128 v[44:47], v9 offset:3200
    s_waitcnt lgkmcnt(4)
    v_mfma_f32_32x32x16_bf16 v[80:95], v[16:19], v[20:23], v[80:95]
    ds_read_b128 v[52:55], v8 offset:544
    ds_read_b128 v[56:59], v9 offset:3232
    s_waitcnt lgkmcnt(4)
    v_mfma_f32_32x32x16_bf16 v[80:95], v[28:31], v[32:35], v[80:95]
    ds_read_b128 v[16:19], v8 offset:448
    ds_read_b128 v[20:23], v9 offset:3120
    s_waitcnt lgkmcnt(4)
    v_mfma_f32_32x32x16_bf16 v[80:95], v[40:43], v[44:47], v[80:95]
    ds_read_b128 v[28:31], v8 offset:480
    ds_read_b128 v[32:35], v9 offset:3152
    s_waitcnt lgkmcnt(4)
    v_mfma_f32_32x32x16_bf16 v[80:95], v[52:55], v[56:59], v[80:95]
    ds_read_b128 v[40:43], v8 offset:384
    ds_read_b128 v[44:47], v9 offset:3040
    s_waitcnt lgkmcnt(4)
    v_mfma_f32_32x32x16_bf16 v[80:95], v[16:19], v[20:23], v[80:95]
    ds_read_b128 v[52:55], v8 offset:416
    ds_read_b128 v[56:59], v9 offset:3072
    s_waitcnt lgkmcnt(4)
    v_mfma_f32_32x32x16_bf16 v[80:95], v[28:31], v[32:35], v[80:95]
    ds_read_b128 v[16:19], v8 offset:320
    ds_read_b128 v[20:23], v9 offset:2960
    s_waitcnt lgkmcnt(4)
    v_mfma_f32_32x32x16_bf16 v[80:95], v[40:43], v[44:47], v[80:95]
    ds_read_b128 v[28:31], v8 offset:352
    ds_read_b128 v[32:35], v9 offset:2992
    s_waitcnt lgkmcnt(4)
    v_mfma_f32_32x32x16_bf16 v[80:95], v[52:55], v[56:59], v[80:95]
    ds_read_b128 v[40:43], v8 offset:256
    ds_read_b128 v[44:47], v9 offset:2880
    s_waitcnt lgkmcnt(4)
    v_mfma_f32_32x32x16_bf16 v[80:95], v[16:19], v[20:23], v[80:95]
    ds_read_b128 v[52:55], v8 offset:288
    ds_read_b128 v[56:59], v9 offset:2912
    s_waitcnt lgkmcnt(4)
    v_mfma_f32_32x32x16_bf16 v[80:95], v[28:31], v[32:35], v[80:95]
    ds_read_b128 v[16:19], v8 offset:192
    ds_read_b128 v[20:23], v9 offset:2800
    s_waitcnt lgkmcnt(4)
    v_mfma_f32_32x32x16_bf16 v[80:95], v[40:43], v[44:47], v[80:95]
    ds_read_b128 v[28:31], v8 offset:224
    ds_read_b128 v[32:35], v9 offset:2832
    s_waitcnt lgkmcnt(4)
    v_mfma_f32_32x32x16_bf16 v[80:95], v[52:55], v[56:59], v[80:95]
    ds_read_b128 v[40:43], v8 offset:128
    ds_read_b128 v[44:47], v9 offset:2720
    s_waitcnt lgkmcnt(4)
    v_mfma_f32_32x32x16_bf16 v[80:95], v[16:19], v[20:23], v[80:95]
    ds_read_b128 v[52:55], v8 offset:160
    ds_read_b128 v[56:59], v9 offset:2752
    s_waitcnt lgkmcnt(4)
    v_mfma_f32_32x32x16_bf16 v[80:95], v[28:31], v[32:35], v[80:95]
    ds_read_b128 v[16:19], v8 offset:64
    ds_read_b128 v[20:23], v9 offset:2640
    s_waitcnt lgkmcnt(4)
    v_mfma_f32_32x32x16_bf16 v[80:95], v[40:43], v[44:47], v[80:95]
    ds_read_b128 v[28:31], v8 offset:96
    ds_read_b128 v[32:35], v9 offset:2672
    s_waitcnt lgkmcnt(4)
    v_mfma_f32_32x32x16_bf16 v[80:95], v[52:55], v[56:59], v[80:95]
    ds_read_b128 v[40:43], v8 offset:0
    ds_read_b128 v[44:47], v9 offset:2560
    s_waitcnt lgkmcnt(4)
    v_mfma_f32_32x32x16_bf16 v[80:95], v[16:19], v[20:23], v[80:95]
    ds_read_b128 v[52:55], v8 offset:32
    ds_read_b128 v[56:59], v9 offset:2592
    s_waitcnt lgkmcnt(4)
    v_mfma_f32_32x32x16_bf16 v[80:95], v[28:31], v[32:35], v[80:95]
    s_waitcnt lgkmcnt(2)
    v_mfma_f32_32x32x16_bf16 v[80:95], v[40:43], v[44:47], v[80:95]
    s_waitcnt lgkmcnt(0)
    v_mfma_f32_32x32x16_bf16 v[80:95], v[52:55], v[56:59], v[80:95]
C1_red:
    s_nop 15
    s_barrier
    s_cmp_eq_u32 s18, 3
    s_cbranch_scc1 C1_skip0
    ds_write_b128 v96, v[64:67] offset:0
    ds_write_b128 v96, v[68:71] offset:1024
    ds_write_b128 v96, v[72:75] offset:2048
    ds_write_b128 v96, v[76:79] offset:3072
C1_skip0:
    ds_write_b128 v96, v[80:83] offset:4096
    ds_write_b128 v96, v[84:87] offset:5120
    ds_write_b128 v96, v[88:91] offset:6144
    ds_write_b128 v96, v[92:95] offset:7168
    s_waitcnt lgkmcnt(0)
    s_barrier
    ds_read_b128 v[16:19], v97 offset:0
    ds_read_b128 v[20:23], v97 offset:1024
    ds_read_b128 v[24:27], v97 offset:8192
    ds_read_b128 v[28:31], v97 offset:9216
    ds_read_b128 v[32:35], v97 offset:16384
    ds_read_b128 v[36:39], v97 offset:17408
    ds_read_b128 v[40:43], v98 offset:0
    ds_read_b128 v[44:47], v98 offset:1024
    ds_read_b64 v[48:49], v15 offset:37888
    ds_read_b64 v[50:51], v15 offset:37904
    s_add_u32 s20, s7, 4096
    s_waitcnt lgkmcnt(0)
    v_add_f32 v16, v16, v24
    v_add_f32 v32, v32, v40
    v_add_f32 v16, v16, v32
    v_add_f32 v17, v17, v25
    v_add_f32 v33, v33, v41
    v_add_f32 v17, v17, v33
    v_add_f32 v18, v18, v26
    v_add_f32 v34, v34, v42
    v_add_f32 v18, v18, v34
    v_add_f32 v19, v19, v27
    v_add_f32 v35, v35, v43
    v_add_f32 v19, v19, v35
    v_add_f32 v20, v20, v28
    v_add_f32 v36, v36, v44
    v_add_f32 v20, v20, v36
    v_add_f32 v21, v21, v29
    v_add_f32 v37, v37, v45
    v_add_f32 v21, v21, v37
    v_add_f32 v22, v22, v30
    v_add_f32 v38, v38, v46
    v_add_f32 v22, v22, v38
    v_add_f32 v23, v23, v31
    v_add_f32 v39, v39, v47
    v_add_f32 v23, v23, v39
    v_lshlrev_b32 v40, 16, v48
    v_and_b32 v41, 0xffff0000, v48
    v_mul_f32 v40, v40, v144
    v_mul_f32 v41, v41, v144
    v_cvt_pk_bf16_f32 v42, v40, v41
    v_lshlrev_b32 v40, 16, v42
    v_and_b32 v41, 0xffff0000, v42
    v_cvt_pk_bf16_f32 v42, v16, v17
    v_lshlrev_b32 v43, 16, v42
    v_and_b32 v44, 0xffff0000, v42
    v_add_f32 v40, v40, v43
    v_add_f32 v41, v41, v44
    v_cvt_pk_bf16_f32 v52, v40, v41
    v_lshlrev_b32 v40, 16, v49
    v_and_b32 v41, 0xffff0000, v49
    v_mul_f32 v40, v40, v144
    v_mul_f32 v41, v41, v144
    v_cvt_pk_bf16_f32 v42, v40, v41
    v_lshlrev_b32 v40, 16, v42
    v_and_b32 v41, 0xffff0000, v42
    v_cvt_pk_bf16_f32 v42, v18, v19
    v_lshlrev_b32 v43, 16, v42
    v_and_b32 v44, 0xffff0000, v42
    v_add_f32 v40, v40, v43
    v_add_f32 v41, v41, v44
    v_cvt_pk_bf16_f32 v53, v40, v41
    buffer_store_dwordx2 v[52:53], v14, s[8:11], s20 offen offset:0 sc1
    v_lshlrev_b32 v40, 16, v50
    v_and_b32 v41, 0xffff0000, v50
    v_mul_f32 v40, v40, v144
    v_mul_f32 v41, v41, v144
    v_cvt_pk_bf16_f32 v42, v40, v41
    v_lshlrev_b32 v40, 16, v42
    v_and_b32 v41, 0xffff0000, v42
    v_cvt_pk_bf16_f32 v42, v20, v21
    v_lshlrev_b32 v43, 16, v42
    v_and_b32 v44, 0xffff0000, v42
    v_add_f32 v40, v40, v43
    v_add_f32 v41, v41, v44
    v_cvt_pk_bf16_f32 v54, v40, v41
    v_lshlrev_b32 v40, 16, v51
    v_and_b32 v41, 0xffff0000, v51
    v_mul_f32 v40, v40, v144
    v_mul_f32 v41, v41, v144
    v_cvt_pk_bf16_f32 v42, v40, v41
    v_lshlrev_b32 v40, 16, v42
    v_and_b32 v41, 0xffff0000, v42
    v_cvt_pk_bf16_f32 v42, v22, v23
    v_lshlrev_b32 v43, 16, v42
    v_and_b32 v44, 0xffff0000, v42
    v_add_f32 v40, v40, v43
    v_add_f32 v41, v41, v44
    v_cvt_pk_bf16_f32 v55, v40, v41
    buffer_store_dwordx2 v[54:55], v14, s[8:11], s20 offen offset:16 sc1
    s_lshr_b32 s19, s19, 5
    s_add_u32 s19, s19, 16
    s_waitcnt vmcnt(0)
    s_barrier
    s_cmp_lg_u32 s18, 0
    s_cbranch_scc1 C_sig
    s_lshl_b32 s20, s19, 7
    s_add_u32 s20, s20, 25100288
    v_mov_b32 v1, s20
    v_mov_b32 v2, 1
    s_mov_b64 exec, 1
    buffer_atomic_add v2, v1, s[8:11], 0 offen
    s_mov_b64 exec, -1
C_sig:
    s_endpgm
M_A:
    s_setprio 3
    s_mov_b32 s4, s36
    s_and_b32 s5, s37, 0xffff
    s_mov_b32 s6, 2097152
    s_mov_b32 s7, 0x00020000
    v_lshrrev_b32 v1, 5, v0
    v_and_b32 v2, 31, v0
    s_lshl_b32 s12, s2, 13
    v_lshlrev_b32 v3, 10, v1
    v_lshl_add_u32 v3, v2, 4, v3
    buffer_load_dwordx4 v[16:19], v3, s[4:7], s12 offen
    buffer_load_dwordx4 v[20:23], v3, s[4:7], s12 offen offset:512
    v_mov_b32 v61, 0
    buffer_load_dword v60, v61, s[84:87], 0 offen sc1
    s_cmp_ge_u32 s2, 224
    s_cbranch_scc1 A_p2
    s_mov_b32 s12, s52
    s_and_b32 s13, s53, 0xffff
    s_mov_b32 s14, 1835008
    s_mov_b32 s15, 0x00020000
    s_mov_b32 s20, 3584
    s_lshr_b32 s5, s2, 4
    s_lshl_b32 s5, s5, 2
    s_and_b32 s6, s2, 3
    s_add_u32 s5, s5, s6
    s_bfe_u32 s6, s2, 0x20002
    s_lshl_b32 s6, s6, 3
    s_lshl_b32 s7, s65, 1
    s_add_u32 s6, s6, s7
    s_lshl_b32 s7, s5, 5
    s_add_u32 s7, s7, s6
    s_lshl_b32 s7, s7, 10
    s_add_u32 s7, s7, 10747904
    v_and_b32 v28, 63, v0
    v_and_b32 v29, 31, v28
    v_lshrrev_b32 v30, 5, v28
    v_lshlrev_b32 v31, 4, v28
    s_lshl_b32 s21, s20, 3
    v_mul_lo_u32 v30, v30, s21
    v_lshl_add_u32 v30, v29, 1, v30
    s_lshl_b32 s5, s5, 6
    v_add_u32 v30, s5, v30
    s_lshl_b32 s6, s6, 4
    s_mul_i32 s6, s6, s20
    buffer_load_ushort v96, v30, s[12:15], s6 offen
    s_add_u32 s6, s6, s20
    buffer_load_ushort v97, v30, s[12:15], s6 offen
    s_add_u32 s6, s6, s20
    buffer_load_ushort v98, v30, s[12:15], s6 offen
    s_add_u32 s6, s6, s20
    buffer_load_ushort v99, v30, s[12:15], s6 offen
    s_add_u32 s6, s6, s20
    buffer_load_ushort v100, v30, s[12:15], s6 offen
    s_add_u32 s6, s6, s20
    buffer_load_ushort v101, v30, s[12:15], s6 offen
    s_add_u32 s6, s6, s20
    buffer_load_ushort v102, v30, s[12:15], s6 offen
    s_add_u32 s6, s6, s20
    buffer_load_ushort v103, v30, s[12:15], s6 offen
    s_add_u32 s6, s6, s20
    s_add_u32 s6, s6, s21
    buffer_load_ushort v104, v30, s[12:15], s6 offen
    s_add_u32 s6, s6, s20
    buffer_load_ushort v105, v30, s[12:15], s6 offen
    s_add_u32 s6, s6, s20
    buffer_load_ushort v106, v30, s[12:15], s6 offen
    s_add_u32 s6, s6, s20
    buffer_load_ushort v107, v30, s[12:15], s6 offen
    s_add_u32 s6, s6, s20
    buffer_load_ushort v108, v30, s[12:15], s6 offen
    s_add_u32 s6, s6, s20
    buffer_load_ushort v109, v30, s[12:15], s6 offen
    s_add_u32 s6, s6, s20
    buffer_load_ushort v110, v30, s[12:15], s6 offen
    s_add_u32 s6, s6, s20
    buffer_load_ushort v111, v30, s[12:15], s6 offen
    s_add_u32 s6, s6, s20
    s_add_u32 s6, s6, s21
    s_waitcnt vmcnt(17)
    v_lshlrev_b32 v64, 16, v16
    v_and_b32 v65, 0xffff0000, v16
    v_lshlrev_b32 v66, 16, v17
    v_and_b32 v67, 0xffff0000, v17
    v_lshlrev_b32 v68, 16, v18
    v_and_b32 v69, 0xffff0000, v18
    v_lshlrev_b32 v70, 16, v19
    v_and_b32 v71, 0xffff0000, v19
    v_lshlrev_b32 v72, 16, v20
    v_and_b32 v73, 0xffff0000, v20
    v_lshlrev_b32 v74, 16, v21
    v_and_b32 v75, 0xffff0000, v21
    v_lshlrev_b32 v76, 16, v22
    v_and_b32 v77, 0xffff0000, v22
    v_lshlrev_b32 v78, 16, v23
    v_and_b32 v79, 0xffff0000, v23
    v_add_f32 v4, v64, v65
    v_add_f32 v5, v66, v67
    v_add_f32 v6, v68, v69
    v_add_f32 v7, v70, v71
    v_add_f32 v4, v4, v6
    v_add_f32 v5, v5, v7
    v_add_f32 v6, v72, v73
    v_add_f32 v7, v74, v75
    v_add_f32 v4, v4, v6
    v_add_f32 v5, v5, v7
    v_add_f32 v6, v76, v77
    v_add_f32 v7, v78, v79
    v_add_f32 v4, v4, v6
    v_add_f32 v5, v5, v7
    v_add_f32 v4, v4, v5
    s_nop 1
    v_add_f32 v4, v4, v4 quad_perm:[1,0,3,2] row_mask:0xf bank_mask:0xf
    s_nop 1
    v_add_f32 v4, v4, v4 quad_perm:[2,3,0,1] row_mask:0xf bank_mask:0xf
    s_nop 1
    v_add_f32 v4, v4, v4 row_half_mirror row_mask:0xf bank_mask:0xf
    s_nop 1
    v_add_f32 v4, v4, v4 row_mirror row_mask:0xf bank_mask:0xf
    ds_swizzle_b32 v5, v4 offset:0x401F
    s_waitcnt lgkmcnt(0)
    v_add_f32 v4, v4, v5
    v_mul_f32 v4, 0x3b000000, v4
    v_sub_f32 v5, v64, v4
    v_sub_f32 v7, v65, v4
    v_mul_f32 v6, v5, v5
    v_mul_f32 v8, v7, v7
    v_sub_f32 v5, v66, v4
    v_sub_f32 v7, v67, v4
    v_fmac_f32 v6, v5, v5
    v_fmac_f32 v8, v7, v7
    v_sub_f32 v5, v68, v4
    v_sub_f32 v7, v69, v4
    v_fmac_f32 v6, v5, v5
    v_fmac_f32 v8, v7, v7
    v_sub_f32 v5, v70, v4
    v_sub_f32 v7, v71, v4
    v_fmac_f32 v6, v5, v5
    v_fmac_f32 v8, v7, v7
    v_sub_f32 v5, v72, v4
    v_sub_f32 v7, v73, v4
    v_fmac_f32 v6, v5, v5
    v_fmac_f32 v8, v7, v7
    v_sub_f32 v5, v74, v4
    v_sub_f32 v7, v75, v4
    v_fmac_f32 v6, v5, v5
    v_fmac_f32 v8, v7, v7
    v_sub_f32 v5, v76, v4
    v_sub_f32 v7, v77, v4
    v_fmac_f32 v6, v5, v5
    v_fmac_f32 v8, v7, v7
    v_sub_f32 v5, v78, v4
    v_sub_f32 v7, v79, v4
    v_fmac_f32 v6, v5, v5
    v_fmac_f32 v8, v7, v7
    v_add_f32 v6, v6, v8
    s_nop 1
    v_add_f32 v6, v6, v6 quad_perm:[1,0,3,2] row_mask:0xf bank_mask:0xf
    s_nop 1
    v_add_f32 v6, v6, v6 quad_perm:[2,3,0,1] row_mask:0xf bank_mask:0xf
    s_nop 1
    v_add_f32 v6, v6, v6 row_half_mirror row_mask:0xf bank_mask:0xf
    s_nop 1
    v_add_f32 v6, v6, v6 row_mirror row_mask:0xf bank_mask:0xf
    ds_swizzle_b32 v5, v6 offset:0x401F
    s_waitcnt lgkmcnt(0)
    v_add_f32 v6, v6, v5
    v_mul_f32 v6, 0x3b000000, v6
    v_cvt_pk_bf16_f32 v4, v4, v4
    v_lshlrev_b32 v4, 16, v4
    v_cvt_pk_bf16_f32 v6, v6, v6
    v_lshlrev_b32 v6, 16, v6
    v_add_f32 v6, 0x3727c5ac, v6
    v_cvt_pk_bf16_f32 v6, v6, v6
    v_lshlrev_b32 v6, 16, v6
    v_sqrt_f32 v6, v6
    s_nop 1
    v_cvt_pk_bf16_f32 v6, v6, v6
    v_lshlrev_b32 v6, 16, v6
    v_rcp_f32 v7, v6
    s_nop 1
    v_sub_f32 v64, v64, v4
    v_sub_f32 v65, v65, v4
    v_cvt_pk_bf16_f32 v8, v64, v65
    v_lshlrev_b32 v64, 16, v8
    v_and_b32 v65, 0xffff0000, v8
    v_mul_f32 v8, v64, v7
    v_mul_f32 v9, v65, v7
    v_fma_f32 v64, -v8, v6, v64
    v_fma_f32 v65, -v9, v6, v65
    v_fma_f32 v8, v64, v7, v8
    v_fma_f32 v9, v65, v7, v9
    v_cvt_pk_bf16_f32 v16, v8, v9
    v_sub_f32 v66, v66, v4
    v_sub_f32 v67, v67, v4
    v_cvt_pk_bf16_f32 v8, v66, v67
    v_lshlrev_b32 v66, 16, v8
    v_and_b32 v67, 0xffff0000, v8
    v_mul_f32 v8, v66, v7
    v_mul_f32 v9, v67, v7
    v_fma_f32 v66, -v8, v6, v66
    v_fma_f32 v67, -v9, v6, v67
    v_fma_f32 v8, v66, v7, v8
    v_fma_f32 v9, v67, v7, v9
    v_cvt_pk_bf16_f32 v17, v8, v9
    v_sub_f32 v68, v68, v4
    v_sub_f32 v69, v69, v4
    v_cvt_pk_bf16_f32 v8, v68, v69
    v_lshlrev_b32 v68, 16, v8
    v_and_b32 v69, 0xffff0000, v8
    v_mul_f32 v8, v68, v7
    v_mul_f32 v9, v69, v7
    v_fma_f32 v68, -v8, v6, v68
    v_fma_f32 v69, -v9, v6, v69
    v_fma_f32 v8, v68, v7, v8
    v_fma_f32 v9, v69, v7, v9
    v_cvt_pk_bf16_f32 v18, v8, v9
    v_sub_f32 v70, v70, v4
    v_sub_f32 v71, v71, v4
    v_cvt_pk_bf16_f32 v8, v70, v71
    v_lshlrev_b32 v70, 16, v8
    v_and_b32 v71, 0xffff0000, v8
    v_mul_f32 v8, v70, v7
    v_mul_f32 v9, v71, v7
    v_fma_f32 v70, -v8, v6, v70
    v_fma_f32 v71, -v9, v6, v71
    v_fma_f32 v8, v70, v7, v8
    v_fma_f32 v9, v71, v7, v9
    v_cvt_pk_bf16_f32 v19, v8, v9
    v_sub_f32 v72, v72, v4
    v_sub_f32 v73, v73, v4
    v_cvt_pk_bf16_f32 v8, v72, v73
    v_lshlrev_b32 v72, 16, v8
    v_and_b32 v73, 0xffff0000, v8
    v_mul_f32 v8, v72, v7
    v_mul_f32 v9, v73, v7
    v_fma_f32 v72, -v8, v6, v72
    v_fma_f32 v73, -v9, v6, v73
    v_fma_f32 v8, v72, v7, v8
    v_fma_f32 v9, v73, v7, v9
    v_cvt_pk_bf16_f32 v20, v8, v9
    v_sub_f32 v74, v74, v4
    v_sub_f32 v75, v75, v4
    v_cvt_pk_bf16_f32 v8, v74, v75
    v_lshlrev_b32 v74, 16, v8
    v_and_b32 v75, 0xffff0000, v8
    v_mul_f32 v8, v74, v7
    v_mul_f32 v9, v75, v7
    v_fma_f32 v74, -v8, v6, v74
    v_fma_f32 v75, -v9, v6, v75
    v_fma_f32 v8, v74, v7, v8
    v_fma_f32 v9, v75, v7, v9
    v_cvt_pk_bf16_f32 v21, v8, v9
    v_sub_f32 v76, v76, v4
    v_sub_f32 v77, v77, v4
    v_cvt_pk_bf16_f32 v8, v76, v77
    v_lshlrev_b32 v76, 16, v8
    v_and_b32 v77, 0xffff0000, v8
    v_mul_f32 v8, v76, v7
    v_mul_f32 v9, v77, v7
    v_fma_f32 v76, -v8, v6, v76
    v_fma_f32 v77, -v9, v6, v77
    v_fma_f32 v8, v76, v7, v8
    v_fma_f32 v9, v77, v7, v9
    v_cvt_pk_bf16_f32 v22, v8, v9
    v_sub_f32 v78, v78, v4
    v_sub_f32 v79, v79, v4
    v_cvt_pk_bf16_f32 v8, v78, v79
    v_lshlrev_b32 v78, 16, v8
    v_and_b32 v79, 0xffff0000, v8
    v_mul_f32 v8, v78, v7
    v_mul_f32 v9, v79, v7
    v_fma_f32 v78, -v8, v6, v78
    v_fma_f32 v79, -v9, v6, v79
    v_fma_f32 v8, v78, v7, v8
    v_fma_f32 v9, v79, v7, v9
    v_cvt_pk_bf16_f32 v23, v8, v9
    v_lshrrev_b32 v12, 1, v2
    v_lshlrev_b32 v12, 10, v12
    v_and_b32 v13, 1, v2
    v_lshl_add_u32 v12, v13, 9, v12
    v_lshl_add_u32 v12, v1, 4, v12
    s_lshr_b32 s12, s2, 2
    s_lshl_b32 s12, s12, 15
    s_and_b32 s13, s2, 3
    s_lshl_b32 s13, s13, 7
    s_add_u32 s12, s12, s13
    s_add_u32 s12, s12, 0
    s_add_u32 s13, s12, 16384
    buffer_store_dwordx4 v[16:19], v12, s[8:11], s12 offen sc1
    buffer_store_dwordx4 v[20:23], v12, s[8:11], s13 offen sc1
    s_waitcnt vmcnt(10)
    v_lshl_or_b32 v24, v97, 16, v96
    v_lshl_or_b32 v25, v99, 16, v98
    v_lshl_or_b32 v26, v101, 16, v100
    v_lshl_or_b32 v27, v103, 16, v102
    buffer_store_dwordx4 v[24:27], v31, s[8:11], s7 offen sc1
    s_add_u32 s7, s7, 1024
    s_waitcnt vmcnt(3)
    v_lshl_or_b32 v24, v105, 16, v104
    v_lshl_or_b32 v25, v107, 16, v106
    v_lshl_or_b32 v26, v109, 16, v108
    v_lshl_or_b32 v27, v111, 16, v110
    buffer_store_dwordx4 v[24:27], v31, s[8:11], s7 offen sc1
    s_add_u32 s7, s7, 1024
    s_waitcnt vmcnt(0)
    s_barrier
    s_cmp_lg_u32 s65, 0
    s_cbranch_scc1 G_pok
    v_readfirstlane_b32 s66, v60
    s_cmp_lg_u32 s66, 0
    s_cbranch_scc1 G_ic_done
    v_mov_b32 v4, 0
    s_mov_b32 s46, 0
G_ic:
    buffer_load_dword v5, v4, s[84:87], 0 offen sc1
    s_waitcnt vmcnt(0)
    v_readfirstlane_b32 s45, v5
    s_cmp_lg_u32 s45, 0
    s_cbranch_scc1 G_ic_ok
    s_add_u32 s46, s46, 1
    s_cmp_ge_u32 s46, 0x20000
    s_cbranch_scc1 G_ic_ok
    s_sleep 2
    s_branch G_ic
G_ic_ok:
    s_mov_b32 s66, 1
G_ic_done:
    s_lshr_b32 s6, s2, 4
    s_add_u32 s6, s6, 24
    s_lshl_b32 s6, s6, 7
    s_add_u32 s6, s6, 25100288
    s_lshr_b32 s5, s2, 4
    s_add_u32 s5, s5, 40
    s_lshl_b32 s5, s5, 7
    s_add_u32 s5, s5, 25100288
    v_and_b32 v7, 1, v0
    v_mov_b32 v4, s6
    v_mov_b32 v6, s5
    v_cmp_eq_u32 vcc, 1, v7
    s_nop 1
    v_cndmask_b32 v4, v4, v6, vcc
    v_mov_b32 v8, 1
    s_mov_b64 exec, 3
    buffer_atomic_add v8, v4, s[8:11], 0 offen
    s_mov_b64 exec, -1
    s_and_b32 s4, s2, 7
    s_lshl_b32 s4, s4, 1
    s_bfe_u32 s5, s2, 0x10003
    s_add_u32 s4, s4, s5
    s_lshr_b32 s5, s2, 4
    s_add_u32 s4, s4, 24
    s_add_u32 s5, s5, 40
    s_lshl_b32 s4, s4, 7
    s_lshl_b32 s5, s5, 7
    s_add_u32 s4, s4, 25100288
    s_add_u32 s5, s5, 25100288
    v_mov_b32 v4, s4
    v_mov_b32 v6, s5
    v_cndmask_b32 v4, v4, v6, vcc
    v_mov_b32 v6, 16
    s_mov_b32 s46, 0
G_pl:
    buffer_load_dword v5, v4, s[8:11], 0 offen sc1
    s_waitcnt vmcnt(0)
    v_cmp_lt_u32 vcc, v5, v6
    s_cbranch_vccz G_pl_ok
    s_add_u32 s46, s46, 1
    s_cmp_ge_u32 s46, 0x20000
    s_cbranch_scc1 G_pl_ok
    s_sleep 2
    s_branch G_pl
G_pl_ok:
G_pok:
    s_barrier
    s_setprio 2
    s_mov_b32 s16, s54
    s_and_b32 s17, s55, 0xffff
    s_mov_b32 s18, 3584
    s_mov_b32 s19, 0x00020000
    s_and_b32 s4, s2, 7
    s_lshl_b32 s4, s4, 1
    s_bfe_u32 s5, s2, 0x10003
    s_add_u32 s4, s4, s5
    s_lshr_b32 s5, s2, 4
    v_lshrrev_b32 v1, 6, v0
    v_and_b32 v2, 63, v0
    v_lshlrev_b32 v3, 4, v2
    v_readfirstlane_b32 s28, v1
    s_lshl_b32 s6, s4, 2
    s_add_u32 s6, s6, s28
    s_lshl_b32 s6, s6, 15
    s_add_u32 s40, s6, 0
    s_lshl_b32 s6, s5, 2
    s_add_u32 s6, s6, s28
    s_lshl_b32 s6, s6, 15
    s_add_u32 s41, s6, 10747904
    s_lshl_b32 s29, s28, 11
    s_add_u32 m0, s29, 0
    s_nop 0
    buffer_load_dwordx4 v3, s[8:11], s40 offen lds
    buffer_load_dwordx4 v3, s[8:11], s40 offen offset:1024 lds
    s_add_u32 m0, s29, 8192
    s_add_u32 s40, s40, 2048
    buffer_load_dwordx4 v3, s[8:11], s41 offen lds
    buffer_load_dwordx4 v3, s[8:11], s41 offen offset:1024 lds
    s_add_u32 s41, s41, 2048
    s_add_u32 m0, s29, 16384
    s_nop 0
    buffer_load_dwordx4 v3, s[8:11], s40 offen lds
    buffer_load_dwordx4 v3, s[8:11], s40 offen offset:1024 lds
    s_add_u32 m0, s29, 24576
    s_add_u32 s40, s40, 2048
    buffer_load_dwordx4 v3, s[8:11], s41 offen lds
    buffer_load_dwordx4 v3, s[8:11], s41 offen offset:1024 lds
    s_add_u32 s41, s41, 2048
    s_add_u32 m0, s29, 32768
    s_nop 0
    buffer_load_dwordx4 v3, s[8:11], s40 offen lds
    buffer_load_dwordx4 v3, s[8:11], s40 offen offset:1024 lds
    s_add_u32 m0, s29, 40960
    s_add_u32 s40, s40, 2048
    buffer_load_dwordx4 v3, s[8:11], s41 offen lds
    buffer_load_dwordx4 v3, s[8:11], s41 offen offset:1024 lds
    s_add_u32 s41, s41, 2048
    s_add_u32 m0, s29, 49152
    s_nop 0
    buffer_load_dwordx4 v3, s[8:11], s40 offen lds
    buffer_load_dwordx4 v3, s[8:11], s40 offen offset:1024 lds
    s_add_u32 m0, s29, 57344
    s_add_u32 s40, s40, 2048
    buffer_load_dwordx4 v3, s[8:11], s41 offen lds
    buffer_load_dwordx4 v3, s[8:11], s41 offen offset:1024 lds
    s_add_u32 s41, s41, 2048
    v_lshrrev_b32 v7, 1, v1
    v_and_b32 v8, 1, v1
    v_and_b32 v15, 31, v0
    v_bfe_u32 v9, v0, 5, 1
    s_lshl_b32 s7, s5, 8
    v_lshlrev_b32 v10, 7, v8
    v_lshl_add_u32 v10, v9, 3, v10
    v_add_u32 v10, s7, v10
    buffer_load_dwordx2 v[48:49], v10, s[16:19], 0 offen offset:0
    buffer_load_dwordx2 v[50:51], v10, s[16:19], 0 offen offset:16
    buffer_load_dwordx2 v[52:53], v10, s[16:19], 0 offen offset:32
    buffer_load_dwordx2 v[54:55], v10, s[16:19], 0 offen offset:48
    buffer_load_dwordx2 v[56:57], v10, s[16:19], 0 offen offset:64
    buffer_load_dwordx2 v[58:59], v10, s[16:19], 0 offen offset:80
    buffer_load_dwordx2 v[60:61], v10, s[16:19], 0 offen offset:96
    buffer_load_dwordx2 v[62:63], v10, s[16:19], 0 offen offset:112
    v_lshl_add_u32 v11, v7, 12, v3
    v_lshl_add_u32 v12, v8, 12, v3
    v_add_u32 v12, 8192, v12
    v_add_u32 v13, 49152, v11
    v_add_u32 v14, 49152, v12
    v_mov_b32 v96, 0
    v_mov_b32 v97, 0
    v_mov_b32 v98, 0
    v_mov_b32 v99, 0
    v_mov_b32 v100, 0
    v_mov_b32 v101, 0
    v_mov_b32 v102, 0
    v_mov_b32 v103, 0
    v_mov_b32 v104, 0
    v_mov_b32 v105, 0
    v_mov_b32 v106, 0
    v_mov_b32 v107, 0
    v_mov_b32 v108, 0
    v_mov_b32 v109, 0
    v_mov_b32 v110, 0
    v_mov_b32 v111, 0
    v_mov_b32 v112, 0
    v_mov_b32 v113, 0
    v_mov_b32 v114, 0
    v_mov_b32 v115, 0
    v_mov_b32 v116, 0
    v_mov_b32 v117, 0
    v_mov_b32 v118, 0
    v_mov_b32 v119, 0
    v_mov_b32 v120, 0
    v_mov_b32 v121, 0
    v_mov_b32 v122, 0
    v_mov_b32 v123, 0
    v_mov_b32 v124, 0
    v_mov_b32 v125, 0
    v_mov_b32 v126, 0
    v_mov_b32 v127, 0
    v_mov_b32 v128, 0
    v_mov_b32 v129, 0
    v_mov_b32 v130, 0
    v_mov_b32 v131, 0
    v_mov_b32 v132, 0
    v_mov_b32 v133, 0
    v_mov_b32 v134, 0
    v_mov_b32 v135, 0
    v_mov_b32 v136, 0
    v_mov_b32 v137, 0
    v_mov_b32 v138, 0
    v_mov_b32 v139, 0
    v_mov_b32 v140, 0
    v_mov_b32 v141, 0
    v_mov_b32 v142, 0
    v_mov_b32 v143, 0
    v_mov_b32 v144, 0
    v_mov_b32 v145, 0
    v_mov_b32 v146, 0
    v_mov_b32 v147, 0
    v_mov_b32 v148, 0
    v_mov_b32 v149, 0
    v_mov_b32 v150, 0
    v_mov_b32 v151, 0
    v_mov_b32 v152, 0
    v_mov_b32 v153, 0
    v_mov_b32 v154, 0
    v_mov_b32 v155, 0
    v_mov_b32 v156, 0
    v_mov_b32 v157, 0
    v_mov_b32 v158, 0
    v_mov_b32 v159, 0
    s_waitcnt vmcnt(20)
    s_barrier
    ds_read_b128 v[16:19], v11 offset:0
    ds_read_b128 v[20:23], v11 offset:2048
    ds_read_b128 v[24:27], v12 offset:0
    ds_read_b128 v[28:31], v12 offset:2048
    s_waitcnt lgkmcnt(0)
    v_mfma_f32_32x32x16_bf16 v[96:111], v[24:27], v[16:19], v[96:111]
    ds_read_b128 v[32:35], v11 offset:1024
    ds_read_b128 v[36:39], v11 offset:3072
    v_mfma_f32_32x32x16_bf16 v[112:127], v[28:31], v[16:19], v[112:127]
    ds_read_b128 v[40:43], v12 offset:1024
    ds_read_b128 v[44:47], v12 offset:3072
    v_mfma_f32_32x32x16_bf16 v[128:143], v[24:27], v[20:23], v[128:143]
    s_waitcnt vmcnt(16)
    s_barrier
    s_add_u32 m0, s29, 65536
    s_nop 0
    buffer_load_dwordx4 v3, s[8:11], s40 offen lds
    buffer_load_dwordx4 v3, s[8:11], s40 offen offset:1024 lds
    v_mfma_f32_32x32x16_bf16 v[144:159], v[28:31], v[20:23], v[144:159]
    s_add_u32 m0, s29, 73728
    s_add_u32 s40, s40, 2048
    buffer_load_dwordx4 v3, s[8:11], s41 offen lds
    buffer_load_dwordx4 v3, s[8:11], s41 offen offset:1024 lds
    s_add_u32 s41, s41, 2048
    s_waitcnt lgkmcnt(0)
    v_mfma_f32_32x32x16_bf16 v[96:111], v[40:43], v[32:35], v[96:111]
    ds_read_b128 v[16:19], v11 offset:16384
    ds_read_b128 v[20:23], v11 offset:18432
    v_mfma_f32_32x32x16_bf16 v[112:127], v[44:47], v[32:35], v[112:127]
    ds_read_b128 v[24:27], v12 offset:16384
    ds_read_b128 v[28:31], v12 offset:18432
    v_mfma_f32_32x32x16_bf16 v[128:143], v[40:43], v[36:39], v[128:143]
    v_mfma_f32_32x32x16_bf16 v[144:159], v[44:47], v[36:39], v[144:159]
    s_waitcnt lgkmcnt(0)
    v_mfma_f32_32x32x16_bf16 v[96:111], v[24:27], v[16:19], v[96:111]
    ds_read_b128 v[32:35], v11 offset:17408
    ds_read_b128 v[36:39], v11 offset:19456
    v_mfma_f32_32x32x16_bf16 v[112:127], v[28:31], v[16:19], v[112:127]
    ds_read_b128 v[40:43], v12 offset:17408
    ds_read_b128 v[44:47], v12 offset:19456
    v_mfma_f32_32x32x16_bf16 v[128:143], v[24:27], v[20:23], v[128:143]
    s_waitcnt vmcnt(16)
    s_barrier
    s_add_u32 m0, s29, 0
    s_nop 0
    buffer_load_dwordx4 v3, s[8:11], s40 offen lds
    buffer_load_dwordx4 v3, s[8:11], s40 offen offset:1024 lds
    v_mfma_f32_32x32x16_bf16 v[144:159], v[28:31], v[20:23], v[144:159]
    s_add_u32 m0, s29, 8192
    s_add_u32 s40, s40, 2048
    buffer_load_dwordx4 v3, s[8:11], s41 offen lds
    buffer_load_dwordx4 v3, s[8:11], s41 offen offset:1024 lds
    s_add_u32 s41, s41, 2048
    s_waitcnt lgkmcnt(0)
    v_mfma_f32_32x32x16_bf16 v[96:111], v[40:43], v[32:35], v[96:111]
    ds_read_b128 v[16:19], v11 offset:32768
    ds_read_b128 v[20:23], v11 offset:34816
    v_mfma_f32_32x32x16_bf16 v[112:127], v[44:47], v[32:35], v[112:127]
    ds_read_b128 v[24:27], v12 offset:32768
    ds_read_b128 v[28:31], v12 offset:34816
    v_mfma_f32_32x32x16_bf16 v[128:143], v[40:43], v[36:39], v[128:143]
    v_mfma_f32_32x32x16_bf16 v[144:159], v[44:47], v[36:39], v[144:159]
    s_waitcnt lgkmcnt(0)
    v_mfma_f32_32x32x16_bf16 v[96:111], v[24:27], v[16:19], v[96:111]
    ds_read_b128 v[32:35], v11 offset:33792
    ds_read_b128 v[36:39], v11 offset:35840
    v_mfma_f32_32x32x16_bf16 v[112:127], v[28:31], v[16:19], v[112:127]
    ds_read_b128 v[40:43], v12 offset:33792
    ds_read_b128 v[44:47], v12 offset:35840
    v_mfma_f32_32x32x16_bf16 v[128:143], v[24:27], v[20:23], v[128:143]
    s_waitcnt vmcnt(16)
    s_barrier
    s_add_u32 m0, s29, 16384
    s_nop 0
    buffer_load_dwordx4 v3, s[8:11], s40 offen lds
    buffer_load_dwordx4 v3, s[8:11], s40 offen offset:1024 lds
    v_mfma_f32_32x32x16_bf16 v[144:159], v[28:31], v[20:23], v[144:159]
    s_add_u32 m0, s29, 24576
    s_add_u32 s40, s40, 2048
    buffer_load_dwordx4 v3, s[8:11], s41 offen lds
    buffer_load_dwordx4 v3, s[8:11], s41 offen offset:1024 lds
    s_add_u32 s41, s41, 2048
    s_waitcnt lgkmcnt(0)
    v_mfma_f32_32x32x16_bf16 v[96:111], v[40:43], v[32:35], v[96:111]
    ds_read_b128 v[16:19], v13 offset:0
    ds_read_b128 v[20:23], v13 offset:2048
    v_mfma_f32_32x32x16_bf16 v[112:127], v[44:47], v[32:35], v[112:127]
    ds_read_b128 v[24:27], v14 offset:0
    ds_read_b128 v[28:31], v14 offset:2048
    v_mfma_f32_32x32x16_bf16 v[128:143], v[40:43], v[36:39], v[128:143]
    v_mfma_f32_32x32x16_bf16 v[144:159], v[44:47], v[36:39], v[144:159]
    s_waitcnt lgkmcnt(0)
    v_mfma_f32_32x32x16_bf16 v[96:111], v[24:27], v[16:19], v[96:111]
    ds_read_b128 v[32:35], v13 offset:1024
    ds_read_b128 v[36:39], v13 offset:3072
    v_mfma_f32_32x32x16_bf16 v[112:127], v[28:31], v[16:19], v[112:127]
    ds_read_b128 v[40:43], v14 offset:1024
    ds_read_b128 v[44:47], v14 offset:3072
    v_mfma_f32_32x32x16_bf16 v[128:143], v[24:27], v[20:23], v[128:143]
    s_waitcnt vmcnt(8)
    s_barrier
    s_add_u32 m0, s29, 32768
    s_nop 0
    buffer_load_dwordx4 v3, s[8:11], s40 offen lds
    buffer_load_dwordx4 v3, s[8:11], s40 offen offset:1024 lds
    v_mfma_f32_32x32x16_bf16 v[144:159], v[28:31], v[20:23], v[144:159]
    s_add_u32 m0, s29, 40960
    s_add_u32 s40, s40, 2048
    buffer_load_dwordx4 v3, s[8:11], s41 offen lds
    buffer_load_dwordx4 v3, s[8:11], s41 offen offset:1024 lds
    s_add_u32 s41, s41, 2048
    s_waitcnt lgkmcnt(0)
    v_mfma_f32_32x32x16_bf16 v[96:111], v[40:43], v[32:35], v[96:111]
    ds_read_b128 v[16:19], v13 offset:16384
    ds_read_b128 v[20:23], v13 offset:18432
    v_mfma_f32_32x32x16_bf16 v[112:127], v[44:47], v[32:35], v[112:127]
    ds_read_b128 v[24:27], v14 offset:16384
    ds_read_b128 v[28:31], v14 offset:18432
    v_mfma_f32_32x32x16_bf16 v[128:143], v[40:43], v[36:39], v[128:143]
    v_mfma_f32_32x32x16_bf16 v[144:159], v[44:47], v[36:39], v[144:159]
    s_waitcnt lgkmcnt(0)
    v_mfma_f32_32x32x16_bf16 v[96:111], v[24:27], v[16:19], v[96:111]
    ds_read_b128 v[32:35], v13 offset:17408
    ds_read_b128 v[36:39], v13 offset:19456
    v_mfma_f32_32x32x16_bf16 v[112:127], v[28:31], v[16:19], v[112:127]
    ds_read_b128 v[40:43], v14 offset:17408
    ds_read_b128 v[44:47], v14 offset:19456
    v_mfma_f32_32x32x16_bf16 v[128:143], v[24:27], v[20:23], v[128:143]
    s_waitcnt vmcnt(8)
    s_barrier
    s_add_u32 m0, s29, 49152
    s_nop 0
    buffer_load_dwordx4 v3, s[8:11], s40 offen lds
    buffer_load_dwordx4 v3, s[8:11], s40 offen offset:1024 lds
    v_mfma_f32_32x32x16_bf16 v[144:159], v[28:31], v[20:23], v[144:159]
    s_add_u32 m0, s29, 57344
    s_add_u32 s40, s40, 2048
    buffer_load_dwordx4 v3, s[8:11], s41 offen lds
    buffer_load_dwordx4 v3, s[8:11], s41 offen offset:1024 lds
    s_add_u32 s41, s41, 2048
    s_waitcnt lgkmcnt(0)
    v_mfma_f32_32x32x16_bf16 v[96:111], v[40:43], v[32:35], v[96:111]
    ds_read_b128 v[16:19], v11 offset:0
    ds_read_b128 v[20:23], v11 offset:2048
    v_mfma_f32_32x32x16_bf16 v[112:127], v[44:47], v[32:35], v[112:127]
    ds_read_b128 v[24:27], v12 offset:0
    ds_read_b128 v[28:31], v12 offset:2048
    v_mfma_f32_32x32x16_bf16 v[128:143], v[40:43], v[36:39], v[128:143]
    v_mfma_f32_32x32x16_bf16 v[144:159], v[44:47], v[36:39], v[144:159]
    s_waitcnt lgkmcnt(0)
    v_mfma_f32_32x32x16_bf16 v[96:111], v[24:27], v[16:19], v[96:111]
    ds_read_b128 v[32:35], v11 offset:1024
    ds_read_b128 v[36:39], v11 offset:3072
    v_mfma_f32_32x32x16_bf16 v[112:127], v[28:31], v[16:19], v[112:127]
    ds_read_b128 v[40:43], v12 offset:1024
    ds_read_b128 v[44:47], v12 offset:3072
    v_mfma_f32_32x32x16_bf16 v[128:143], v[24:27], v[20:23], v[128:143]
    s_waitcnt vmcnt(8)
    s_barrier
    s_add_u32 m0, s29, 65536
    s_nop 0
    buffer_load_dwordx4 v3, s[8:11], s40 offen lds
    buffer_load_dwordx4 v3, s[8:11], s40 offen offset:1024 lds
    v_mfma_f32_32x32x16_bf16 v[144:159], v[28:31], v[20:23], v[144:159]
    s_add_u32 m0, s29, 73728
    s_add_u32 s40, s40, 2048
    buffer_load_dwordx4 v3, s[8:11], s41 offen lds
    buffer_load_dwordx4 v3, s[8:11], s41 offen offset:1024 lds
    s_add_u32 s41, s41, 2048
    s_waitcnt lgkmcnt(0)
    v_mfma_f32_32x32x16_bf16 v[96:111], v[40:43], v[32:35], v[96:111]
    ds_read_b128 v[16:19], v11 offset:16384
    ds_read_b128 v[20:23], v11 offset:18432
    v_mfma_f32_32x32x16_bf16 v[112:127], v[44:47], v[32:35], v[112:127]
    ds_read_b128 v[24:27], v12 offset:16384
    ds_read_b128 v[28:31], v12 offset:18432
    v_mfma_f32_32x32x16_bf16 v[128:143], v[40:43], v[36:39], v[128:143]
    v_mfma_f32_32x32x16_bf16 v[144:159], v[44:47], v[36:39], v[144:159]
    s_waitcnt lgkmcnt(0)
    v_mfma_f32_32x32x16_bf16 v[96:111], v[24:27], v[16:19], v[96:111]
    ds_read_b128 v[32:35], v11 offset:17408
    ds_read_b128 v[36:39], v11 offset:19456
    v_mfma_f32_32x32x16_bf16 v[112:127], v[28:31], v[16:19], v[112:127]
    ds_read_b128 v[40:43], v12 offset:17408
    ds_read_b128 v[44:47], v12 offset:19456
    v_mfma_f32_32x32x16_bf16 v[128:143], v[24:27], v[20:23], v[128:143]
    s_waitcnt vmcnt(8)
    s_barrier
    s_add_u32 m0, s29, 0
    s_nop 0
    buffer_load_dwordx4 v3, s[8:11], s40 offen lds
    buffer_load_dwordx4 v3, s[8:11], s40 offen offset:1024 lds
    v_mfma_f32_32x32x16_bf16 v[144:159], v[28:31], v[20:23], v[144:159]
    s_add_u32 m0, s29, 8192
    s_add_u32 s40, s40, 2048
    buffer_load_dwordx4 v3, s[8:11], s41 offen lds
    buffer_load_dwordx4 v3, s[8:11], s41 offen offset:1024 lds
    s_add_u32 s41, s41, 2048
    s_waitcnt lgkmcnt(0)
    v_mfma_f32_32x32x16_bf16 v[96:111], v[40:43], v[32:35], v[96:111]
    ds_read_b128 v[16:19], v11 offset:32768
    ds_read_b128 v[20:23], v11 offset:34816
    v_mfma_f32_32x32x16_bf16 v[112:127], v[44:47], v[32:35], v[112:127]
    ds_read_b128 v[24:27], v12 offset:32768
    ds_read_b128 v[28:31], v12 offset:34816
    v_mfma_f32_32x32x16_bf16 v[128:143], v[40:43], v[36:39], v[128:143]
    v_mfma_f32_32x32x16_bf16 v[144:159], v[44:47], v[36:39], v[144:159]
    s_waitcnt lgkmcnt(0)
    v_mfma_f32_32x32x16_bf16 v[96:111], v[24:27], v[16:19], v[96:111]
    ds_read_b128 v[32:35], v11 offset:33792
    ds_read_b128 v[36:39], v11 offset:35840
    v_mfma_f32_32x32x16_bf16 v[112:127], v[28:31], v[16:19], v[112:127]
    ds_read_b128 v[40:43], v12 offset:33792
    ds_read_b128 v[44:47], v12 offset:35840
    v_mfma_f32_32x32x16_bf16 v[128:143], v[24:27], v[20:23], v[128:143]
    s_waitcnt vmcnt(8)
    s_barrier
    s_add_u32 m0, s29, 16384
    s_nop 0
    buffer_load_dwordx4 v3, s[8:11], s40 offen lds
    buffer_load_dwordx4 v3, s[8:11], s40 offen offset:1024 lds
    v_mfma_f32_32x32x16_bf16 v[144:159], v[28:31], v[20:23], v[144:159]
    s_add_u32 m0, s29, 24576
    s_add_u32 s40, s40, 2048
    buffer_load_dwordx4 v3, s[8:11], s41 offen lds
    buffer_load_dwordx4 v3, s[8:11], s41 offen offset:1024 lds
    s_add_u32 s41, s41, 2048
    s_waitcnt lgkmcnt(0)
    v_mfma_f32_32x32x16_bf16 v[96:111], v[40:43], v[32:35], v[96:111]
    ds_read_b128 v[16:19], v13 offset:0
    ds_read_b128 v[20:23], v13 offset:2048
    v_mfma_f32_32x32x16_bf16 v[112:127], v[44:47], v[32:35], v[112:127]
    ds_read_b128 v[24:27], v14 offset:0
    ds_read_b128 v[28:31], v14 offset:2048
    v_mfma_f32_32x32x16_bf16 v[128:143], v[40:43], v[36:39], v[128:143]
    v_mfma_f32_32x32x16_bf16 v[144:159], v[44:47], v[36:39], v[144:159]
    s_waitcnt lgkmcnt(0)
    v_mfma_f32_32x32x16_bf16 v[96:111], v[24:27], v[16:19], v[96:111]
    ds_read_b128 v[32:35], v13 offset:1024
    ds_read_b128 v[36:39], v13 offset:3072
    v_mfma_f32_32x32x16_bf16 v[112:127], v[28:31], v[16:19], v[112:127]
    ds_read_b128 v[40:43], v14 offset:1024
    ds_read_b128 v[44:47], v14 offset:3072
    v_mfma_f32_32x32x16_bf16 v[128:143], v[24:27], v[20:23], v[128:143]
    s_waitcnt vmcnt(8)
    s_barrier
    s_add_u32 m0, s29, 32768
    s_nop 0
    buffer_load_dwordx4 v3, s[8:11], s40 offen lds
    buffer_load_dwordx4 v3, s[8:11], s40 offen offset:1024 lds
    v_mfma_f32_32x32x16_bf16 v[144:159], v[28:31], v[20:23], v[144:159]
    s_add_u32 m0, s29, 40960
    s_add_u32 s40, s40, 2048
    buffer_load_dwordx4 v3, s[8:11], s41 offen lds
    buffer_load_dwordx4 v3, s[8:11], s41 offen offset:1024 lds
    s_add_u32 s41, s41, 2048
    s_waitcnt lgkmcnt(0)
    v_mfma_f32_32x32x16_bf16 v[96:111], v[40:43], v[32:35], v[96:111]
    ds_read_b128 v[16:19], v13 offset:16384
    ds_read_b128 v[20:23], v13 offset:18432
    v_mfma_f32_32x32x16_bf16 v[112:127], v[44:47], v[32:35], v[112:127]
    ds_read_b128 v[24:27], v14 offset:16384
    ds_read_b128 v[28:31], v14 offset:18432
    v_mfma_f32_32x32x16_bf16 v[128:143], v[40:43], v[36:39], v[128:143]
    v_mfma_f32_32x32x16_bf16 v[144:159], v[44:47], v[36:39], v[144:159]
    s_waitcnt lgkmcnt(0)
    v_mfma_f32_32x32x16_bf16 v[96:111], v[24:27], v[16:19], v[96:111]
    ds_read_b128 v[32:35], v13 offset:17408
    ds_read_b128 v[36:39], v13 offset:19456
    v_mfma_f32_32x32x16_bf16 v[112:127], v[28:31], v[16:19], v[112:127]
    ds_read_b128 v[40:43], v14 offset:17408
    ds_read_b128 v[44:47], v14 offset:19456
    v_mfma_f32_32x32x16_bf16 v[128:143], v[24:27], v[20:23], v[128:143]
    s_waitcnt vmcnt(8)
    s_barrier
    s_add_u32 m0, s29, 49152
    s_nop 0
    buffer_load_dwordx4 v3, s[8:11], s40 offen lds
    buffer_load_dwordx4 v3, s[8:11], s40 offen offset:1024 lds
    v_mfma_f32_32x32x16_bf16 v[144:159], v[28:31], v[20:23], v[144:159]
    s_add_u32 m0, s29, 57344
    s_add_u32 s40, s40, 2048
    buffer_load_dwordx4 v3, s[8:11], s41 offen lds
    buffer_load_dwordx4 v3, s[8:11], s41 offen offset:1024 lds
    s_add_u32 s41, s41, 2048
    s_waitcnt lgkmcnt(0)
    v_mfma_f32_32x32x16_bf16 v[96:111], v[40:43], v[32:35], v[96:111]
    ds_read_b128 v[16:19], v11 offset:0
    ds_read_b128 v[20:23], v11 offset:2048
    v_mfma_f32_32x32x16_bf16 v[112:127], v[44:47], v[32:35], v[112:127]
    ds_read_b128 v[24:27], v12 offset:0
    ds_read_b128 v[28:31], v12 offset:2048
    v_mfma_f32_32x32x16_bf16 v[128:143], v[40:43], v[36:39], v[128:143]
    v_mfma_f32_32x32x16_bf16 v[144:159], v[44:47], v[36:39], v[144:159]
    s_waitcnt lgkmcnt(0)
    v_mfma_f32_32x32x16_bf16 v[96:111], v[24:27], v[16:19], v[96:111]
    ds_read_b128 v[32:35], v11 offset:1024
    ds_read_b128 v[36:39], v11 offset:3072
    v_mfma_f32_32x32x16_bf16 v[112:127], v[28:31], v[16:19], v[112:127]
    ds_read_b128 v[40:43], v12 offset:1024
    ds_read_b128 v[44:47], v12 offset:3072
    v_mfma_f32_32x32x16_bf16 v[128:143], v[24:27], v[20:23], v[128:143]
    s_waitcnt vmcnt(8)
    s_barrier
    s_add_u32 m0, s29, 65536
    s_nop 0
    buffer_load_dwordx4 v3, s[8:11], s40 offen lds
    buffer_load_dwordx4 v3, s[8:11], s40 offen offset:1024 lds
    v_mfma_f32_32x32x16_bf16 v[144:159], v[28:31], v[20:23], v[144:159]
    s_add_u32 m0, s29, 73728
    s_add_u32 s40, s40, 2048
    buffer_load_dwordx4 v3, s[8:11], s41 offen lds
    buffer_load_dwordx4 v3, s[8:11], s41 offen offset:1024 lds
    s_add_u32 s41, s41, 2048
    s_waitcnt lgkmcnt(0)
    v_mfma_f32_32x32x16_bf16 v[96:111], v[40:43], v[32:35], v[96:111]
    ds_read_b128 v[16:19], v11 offset:16384
    ds_read_b128 v[20:23], v11 offset:18432
    v_mfma_f32_32x32x16_bf16 v[112:127], v[44:47], v[32:35], v[112:127]
    ds_read_b128 v[24:27], v12 offset:16384
    ds_read_b128 v[28:31], v12 offset:18432
    v_mfma_f32_32x32x16_bf16 v[128:143], v[40:43], v[36:39], v[128:143]
    v_mfma_f32_32x32x16_bf16 v[144:159], v[44:47], v[36:39], v[144:159]
    s_waitcnt lgkmcnt(0)
    v_mfma_f32_32x32x16_bf16 v[96:111], v[24:27], v[16:19], v[96:111]
    ds_read_b128 v[32:35], v11 offset:17408
    ds_read_b128 v[36:39], v11 offset:19456
    v_mfma_f32_32x32x16_bf16 v[112:127], v[28:31], v[16:19], v[112:127]
    ds_read_b128 v[40:43], v12 offset:17408
    ds_read_b128 v[44:47], v12 offset:19456
    v_mfma_f32_32x32x16_bf16 v[128:143], v[24:27], v[20:23], v[128:143]
    s_waitcnt vmcnt(8)
    s_barrier
    s_add_u32 m0, s29, 0
    s_nop 0
    buffer_load_dwordx4 v3, s[8:11], s40 offen lds
    buffer_load_dwordx4 v3, s[8:11], s40 offen offset:1024 lds
    v_mfma_f32_32x32x16_bf16 v[144:159], v[28:31], v[20:23], v[144:159]
    s_add_u32 m0, s29, 8192
    s_add_u32 s40, s40, 2048
    buffer_load_dwordx4 v3, s[8:11], s41 offen lds
    buffer_load_dwordx4 v3, s[8:11], s41 offen offset:1024 lds
    s_add_u32 s41, s41, 2048
    s_waitcnt lgkmcnt(0)
    v_mfma_f32_32x32x16_bf16 v[96:111], v[40:43], v[32:35], v[96:111]
    ds_read_b128 v[16:19], v11 offset:32768
    ds_read_b128 v[20:23], v11 offset:34816
    v_mfma_f32_32x32x16_bf16 v[112:127], v[44:47], v[32:35], v[112:127]
    ds_read_b128 v[24:27], v12 offset:32768
    ds_read_b128 v[28:31], v12 offset:34816
    v_mfma_f32_32x32x16_bf16 v[128:143], v[40:43], v[36:39], v[128:143]
    v_mfma_f32_32x32x16_bf16 v[144:159], v[44:47], v[36:39], v[144:159]
    s_waitcnt lgkmcnt(0)
    v_mfma_f32_32x32x16_bf16 v[96:111], v[24:27], v[16:19], v[96:111]
    ds_read_b128 v[32:35], v11 offset:33792
    ds_read_b128 v[36:39], v11 offset:35840
    v_mfma_f32_32x32x16_bf16 v[112:127], v[28:31], v[16:19], v[112:127]
    ds_read_b128 v[40:43], v12 offset:33792
    ds_read_b128 v[44:47], v12 offset:35840
    v_mfma_f32_32x32x16_bf16 v[128:143], v[24:27], v[20:23], v[128:143]
    s_waitcnt vmcnt(8)
    s_barrier
    v_mfma_f32_32x32x16_bf16 v[144:159], v[28:31], v[20:23], v[144:159]
    s_waitcnt lgkmcnt(0)
    v_mfma_f32_32x32x16_bf16 v[96:111], v[40:43], v[32:35], v[96:111]
    ds_read_b128 v[16:19], v13 offset:0
    ds_read_b128 v[20:23], v13 offset:2048
    v_mfma_f32_32x32x16_bf16 v[112:127], v[44:47], v[32:35], v[112:127]
    ds_read_b128 v[24:27], v14 offset:0
    ds_read_b128 v[28:31], v14 offset:2048
    v_mfma_f32_32x32x16_bf16 v[128:143], v[40:43], v[36:39], v[128:143]
    v_mfma_f32_32x32x16_bf16 v[144:159], v[44:47], v[36:39], v[144:159]
    s_waitcnt lgkmcnt(0)
    v_mfma_f32_32x32x16_bf16 v[96:111], v[24:27], v[16:19], v[96:111]
    ds_read_b128 v[32:35], v13 offset:1024
    ds_read_b128 v[36:39], v13 offset:3072
    v_mfma_f32_32x32x16_bf16 v[112:127], v[28:31], v[16:19], v[112:127]
    ds_read_b128 v[40:43], v14 offset:1024
    ds_read_b128 v[44:47], v14 offset:3072
    v_mfma_f32_32x32x16_bf16 v[128:143], v[24:27], v[20:23], v[128:143]
    s_waitcnt vmcnt(4)
    s_barrier
    v_mfma_f32_32x32x16_bf16 v[144:159], v[28:31], v[20:23], v[144:159]
    s_waitcnt lgkmcnt(0)
    v_mfma_f32_32x32x16_bf16 v[96:111], v[40:43], v[32:35], v[96:111]
    ds_read_b128 v[16:19], v13 offset:16384
    ds_read_b128 v[20:23], v13 offset:18432
    v_mfma_f32_32x32x16_bf16 v[112:127], v[44:47], v[32:35], v[112:127]
    ds_read_b128 v[24:27], v14 offset:16384
    ds_read_b128 v[28:31], v14 offset:18432
    v_mfma_f32_32x32x16_bf16 v[128:143], v[40:43], v[36:39], v[128:143]
    v_mfma_f32_32x32x16_bf16 v[144:159], v[44:47], v[36:39], v[144:159]
    s_waitcnt lgkmcnt(0)
    v_mfma_f32_32x32x16_bf16 v[96:111], v[24:27], v[16:19], v[96:111]
    ds_read_b128 v[32:35], v13 offset:17408
    ds_read_b128 v[36:39], v13 offset:19456
    v_mfma_f32_32x32x16_bf16 v[112:127], v[28:31], v[16:19], v[112:127]
    ds_read_b128 v[40:43], v14 offset:17408
    ds_read_b128 v[44:47], v14 offset:19456
    v_mfma_f32_32x32x16_bf16 v[128:143], v[24:27], v[20:23], v[128:143]
    s_waitcnt vmcnt(0)
    s_barrier
    v_mfma_f32_32x32x16_bf16 v[144:159], v[28:31], v[20:23], v[144:159]
    s_waitcnt lgkmcnt(0)
    v_mfma_f32_32x32x16_bf16 v[96:111], v[40:43], v[32:35], v[96:111]
    ds_read_b128 v[16:19], v11 offset:0
    ds_read_b128 v[20:23], v11 offset:2048
    v_mfma_f32_32x32x16_bf16 v[112:127], v[44:47], v[32:35], v[112:127]
    ds_read_b128 v[24:27], v12 offset:0
    ds_read_b128 v[28:31], v12 offset:2048
    v_mfma_f32_32x32x16_bf16 v[128:143], v[40:43], v[36:39], v[128:143]
    v_mfma_f32_32x32x16_bf16 v[144:159], v[44:47], v[36:39], v[144:159]
    s_waitcnt lgkmcnt(0)
    v_mfma_f32_32x32x16_bf16 v[96:111], v[24:27], v[16:19], v[96:111]
    ds_read_b128 v[32:35], v11 offset:1024
    ds_read_b128 v[36:39], v11 offset:3072
    v_mfma_f32_32x32x16_bf16 v[112:127], v[28:31], v[16:19], v[112:127]
    ds_read_b128 v[40:43], v12 offset:1024
    ds_read_b128 v[44:47], v12 offset:3072
    v_mfma_f32_32x32x16_bf16 v[128:143], v[24:27], v[20:23], v[128:143]
    v_mfma_f32_32x32x16_bf16 v[144:159], v[28:31], v[20:23], v[144:159]
    s_waitcnt lgkmcnt(0)
    v_mfma_f32_32x32x16_bf16 v[96:111], v[40:43], v[32:35], v[96:111]
    v_mfma_f32_32x32x16_bf16 v[112:127], v[44:47], v[32:35], v[112:127]
    v_mfma_f32_32x32x16_bf16 v[128:143], v[40:43], v[36:39], v[128:143]
    v_mfma_f32_32x32x16_bf16 v[144:159], v[44:47], v[36:39], v[144:159]
    v_and_b32 v20, 63, v0
    v_lshlrev_b32 v20, 4, v20
    s_lshl_b32 s26, s4, 2
    s_and_b32 s24, s28, 2
    s_add_u32 s26, s26, s24
    s_mul_i32 s26, s26, 112
    s_lshl_b32 s27, s5, 3
    s_add_u32 s26, s26, s27
    s_and_b32 s25, s28, 1
    s_lshl_b32 s25, s25, 2
    s_add_u32 s26, s26, s25
    s_lshl_b32 s26, s26, 10
    s_add_u32 s26, s26, 12582912
    s_add_u32 s27, s26, 114688
    s_waitcnt vmcnt(0)
    v_lshlrev_b32 v64, 16, v48
    v_and_b32 v65, 0xffff0000, v48
    v_lshlrev_b32 v66, 16, v49
    v_and_b32 v67, 0xffff0000, v49
    v_lshlrev_b32 v68, 16, v50
    v_and_b32 v69, 0xffff0000, v50
    v_lshlrev_b32 v70, 16, v51
    v_and_b32 v71, 0xffff0000, v51
    v_lshlrev_b32 v72, 16, v52
    v_and_b32 v73, 0xffff0000, v52
    v_lshlrev_b32 v74, 16, v53
    v_and_b32 v75, 0xffff0000, v53
    v_lshlrev_b32 v76, 16, v54
    v_and_b32 v77, 0xffff0000, v54
    v_lshlrev_b32 v78, 16, v55
    v_and_b32 v79, 0xffff0000, v55
    v_lshlrev_b32 v80, 16, v56
    v_and_b32 v81, 0xffff0000, v56
    v_lshlrev_b32 v82, 16, v57
    v_and_b32 v83, 0xffff0000, v57
    v_lshlrev_b32 v84, 16, v58
    v_and_b32 v85, 0xffff0000, v58
    v_lshlrev_b32 v86, 16, v59
    v_and_b32 v87, 0xffff0000, v59
    v_lshlrev_b32 v88, 16, v60
    v_and_b32 v89, 0xffff0000, v60
    v_lshlrev_b32 v90, 16, v61
    v_and_b32 v91, 0xffff0000, v61
    v_lshlrev_b32 v92, 16, v62
    v_and_b32 v93, 0xffff0000, v62
    v_lshlrev_b32 v94, 16, v63
    v_and_b32 v95, 0xffff0000, v63
    v_mov_b32 v16, 0xc0135761
    v_mov_b32 v17, 0xc0135761
    s_mov_b32 s22, 0xbdd2d3e8
    s_mov_b32 s23, 0xbdd2d3e8
    v_mov_b32 v18, 1.0
    v_mov_b32 v19, 1.0
    v_cvt_pk_bf16_f32 v32, v96, v97
    v_cvt_pk_bf16_f32 v33, v98, v99
    v_lshlrev_b32 v24, 16, v32
    v_and_b32 v25, 0xffff0000, v32
    v_lshlrev_b32 v28, 16, v33
    v_and_b32 v29, 0xffff0000, v33
    v_pk_add_f32 v[24:25], v[24:25], v[64:65]
    v_pk_add_f32 v[28:29], v[28:29], v[66:67]
    v_cvt_pk_bf16_f32 v32, v24, v25
    v_cvt_pk_bf16_f32 v33, v28, v29
    v_lshlrev_b32 v24, 16, v32
    v_and_b32 v25, 0xffff0000, v32
    v_lshlrev_b32 v28, 16, v33
    v_and_b32 v29, 0xffff0000, v33
    v_pk_mul_f32 v[26:27], v[24:25], v[24:25]
    v_pk_mul_f32 v[30:31], v[28:29], v[28:29]
    v_pk_fma_f32 v[26:27], v[26:27], s[22:23], v[16:17]
    v_pk_fma_f32 v[30:31], v[30:31], s[22:23], v[16:17]
    v_pk_mul_f32 v[26:27], v[26:27], v[24:25]
    v_pk_mul_f32 v[30:31], v[30:31], v[28:29]
    v_exp_f32 v26, v26
    v_exp_f32 v27, v27
    v_exp_f32 v30, v30
    v_exp_f32 v31, v31
    v_pk_add_f32 v[26:27], v[26:27], v[18:19]
    v_pk_add_f32 v[30:31], v[30:31], v[18:19]
    v_rcp_f32 v26, v26
    v_rcp_f32 v27, v27
    v_rcp_f32 v30, v30
    v_rcp_f32 v31, v31
    v_pk_mul_f32 v[24:25], v[24:25], v[26:27]
    v_pk_mul_f32 v[28:29], v[28:29], v[30:31]
    v_cvt_pk_bf16_f32 v160, v24, v25
    v_cvt_pk_bf16_f32 v161, v28, v29
    v_cvt_pk_bf16_f32 v32, v100, v101
    v_cvt_pk_bf16_f32 v33, v102, v103
    v_lshlrev_b32 v24, 16, v32
    v_and_b32 v25, 0xffff0000, v32
    v_lshlrev_b32 v28, 16, v33
    v_and_b32 v29, 0xffff0000, v33
    v_pk_add_f32 v[24:25], v[24:25], v[68:69]
    v_pk_add_f32 v[28:29], v[28:29], v[70:71]
    v_cvt_pk_bf16_f32 v32, v24, v25
    v_cvt_pk_bf16_f32 v33, v28, v29
    v_lshlrev_b32 v24, 16, v32
    v_and_b32 v25, 0xffff0000, v32
    v_lshlrev_b32 v28, 16, v33
    v_and_b32 v29, 0xffff0000, v33
    v_pk_mul_f32 v[26:27], v[24:25], v[24:25]
    v_pk_mul_f32 v[30:31], v[28:29], v[28:29]
    v_pk_fma_f32 v[26:27], v[26:27], s[22:23], v[16:17]
    v_pk_fma_f32 v[30:31], v[30:31], s[22:23], v[16:17]
    v_pk_mul_f32 v[26:27], v[26:27], v[24:25]
    v_pk_mul_f32 v[30:31], v[30:31], v[28:29]
    v_exp_f32 v26, v26
    v_exp_f32 v27, v27
    v_exp_f32 v30, v30
    v_exp_f32 v31, v31
    v_pk_add_f32 v[26:27], v[26:27], v[18:19]
    v_pk_add_f32 v[30:31], v[30:31], v[18:19]
    v_rcp_f32 v26, v26
    v_rcp_f32 v27, v27
    v_rcp_f32 v30, v30
    v_rcp_f32 v31, v31
    v_pk_mul_f32 v[24:25], v[24:25], v[26:27]
    v_pk_mul_f32 v[28:29], v[28:29], v[30:31]
    v_cvt_pk_bf16_f32 v162, v24, v25
    v_cvt_pk_bf16_f32 v163, v28, v29
    s_nop 1
    v_permlane32_swap_b32 v160, v162
    v_permlane32_swap_b32 v161, v163
    buffer_store_dwordx4 v[160:163], v20, s[8:11], s26 offen offset:0 sc1
    v_cvt_pk_bf16_f32 v32, v104, v105
    v_cvt_pk_bf16_f32 v33, v106, v107
    v_lshlrev_b32 v24, 16, v32
    v_and_b32 v25, 0xffff0000, v32
    v_lshlrev_b32 v28, 16, v33
    v_and_b32 v29, 0xffff0000, v33
    v_pk_add_f32 v[24:25], v[24:25], v[72:73]
    v_pk_add_f32 v[28:29], v[28:29], v[74:75]
    v_cvt_pk_bf16_f32 v32, v24, v25
    v_cvt_pk_bf16_f32 v33, v28, v29
    v_lshlrev_b32 v24, 16, v32
    v_and_b32 v25, 0xffff0000, v32
    v_lshlrev_b32 v28, 16, v33
    v_and_b32 v29, 0xffff0000, v33
    v_pk_mul_f32 v[26:27], v[24:25], v[24:25]
    v_pk_mul_f32 v[30:31], v[28:29], v[28:29]
    v_pk_fma_f32 v[26:27], v[26:27], s[22:23], v[16:17]
    v_pk_fma_f32 v[30:31], v[30:31], s[22:23], v[16:17]
    v_pk_mul_f32 v[26:27], v[26:27], v[24:25]
    v_pk_mul_f32 v[30:31], v[30:31], v[28:29]
    v_exp_f32 v26, v26
    v_exp_f32 v27, v27
    v_exp_f32 v30, v30
    v_exp_f32 v31, v31
    v_pk_add_f32 v[26:27], v[26:27], v[18:19]
    v_pk_add_f32 v[30:31], v[30:31], v[18:19]
    v_rcp_f32 v26, v26
    v_rcp_f32 v27, v27
    v_rcp_f32 v30, v30
    v_rcp_f32 v31, v31
    v_pk_mul_f32 v[24:25], v[24:25], v[26:27]
    v_pk_mul_f32 v[28:29], v[28:29], v[30:31]
    v_cvt_pk_bf16_f32 v164, v24, v25
    v_cvt_pk_bf16_f32 v165, v28, v29
    v_cvt_pk_bf16_f32 v32, v108, v109
    v_cvt_pk_bf16_f32 v33, v110, v111
    v_lshlrev_b32 v24, 16, v32
    v_and_b32 v25, 0xffff0000, v32
    v_lshlrev_b32 v28, 16, v33
    v_and_b32 v29, 0xffff0000, v33
    v_pk_add_f32 v[24:25], v[24:25], v[76:77]
    v_pk_add_f32 v[28:29], v[28:29], v[78:79]
    v_cvt_pk_bf16_f32 v32, v24, v25
    v_cvt_pk_bf16_f32 v33, v28, v29
    v_lshlrev_b32 v24, 16, v32
    v_and_b32 v25, 0xffff0000, v32
    v_lshlrev_b32 v28, 16, v33
    v_and_b32 v29, 0xffff0000, v33
    v_pk_mul_f32 v[26:27], v[24:25], v[24:25]
    v_pk_mul_f32 v[30:31], v[28:29], v[28:29]
    v_pk_fma_f32 v[26:27], v[26:27], s[22:23], v[16:17]
    v_pk_fma_f32 v[30:31], v[30:31], s[22:23], v[16:17]
    v_pk_mul_f32 v[26:27], v[26:27], v[24:25]
    v_pk_mul_f32 v[30:31], v[30:31], v[28:29]
    v_exp_f32 v26, v26
    v_exp_f32 v27, v27
    v_exp_f32 v30, v30
    v_exp_f32 v31, v31
    v_pk_add_f32 v[26:27], v[26:27], v[18:19]
    v_pk_add_f32 v[30:31], v[30:31], v[18:19]
    v_rcp_f32 v26, v26
    v_rcp_f32 v27, v27
    v_rcp_f32 v30, v30
    v_rcp_f32 v31, v31
    v_pk_mul_f32 v[24:25], v[24:25], v[26:27]
    v_pk_mul_f32 v[28:29], v[28:29], v[30:31]
    v_cvt_pk_bf16_f32 v166, v24, v25
    v_cvt_pk_bf16_f32 v167, v28, v29
    s_nop 1
    v_permlane32_swap_b32 v164, v166
    v_permlane32_swap_b32 v165, v167
    buffer_store_dwordx4 v[164:167], v20, s[8:11], s26 offen offset:1024 sc1
    v_cvt_pk_bf16_f32 v32, v112, v113
    v_cvt_pk_bf16_f32 v33, v114, v115
    v_lshlrev_b32 v24, 16, v32
    v_and_b32 v25, 0xffff0000, v32
    v_lshlrev_b32 v28, 16, v33
    v_and_b32 v29, 0xffff0000, v33
    v_pk_add_f32 v[24:25], v[24:25], v[80:81]
    v_pk_add_f32 v[28:29], v[28:29], v[82:83]
    v_cvt_pk_bf16_f32 v32, v24, v25
    v_cvt_pk_bf16_f32 v33, v28, v29
    v_lshlrev_b32 v24, 16, v32
    v_and_b32 v25, 0xffff0000, v32
    v_lshlrev_b32 v28, 16, v33
    v_and_b32 v29, 0xffff0000, v33
    v_pk_mul_f32 v[26:27], v[24:25], v[24:25]
    v_pk_mul_f32 v[30:31], v[28:29], v[28:29]
    v_pk_fma_f32 v[26:27], v[26:27], s[22:23], v[16:17]
    v_pk_fma_f32 v[30:31], v[30:31], s[22:23], v[16:17]
    v_pk_mul_f32 v[26:27], v[26:27], v[24:25]
    v_pk_mul_f32 v[30:31], v[30:31], v[28:29]
    v_exp_f32 v26, v26
    v_exp_f32 v27, v27
    v_exp_f32 v30, v30
    v_exp_f32 v31, v31
    v_pk_add_f32 v[26:27], v[26:27], v[18:19]
    v_pk_add_f32 v[30:31], v[30:31], v[18:19]
    v_rcp_f32 v26, v26
    v_rcp_f32 v27, v27
    v_rcp_f32 v30, v30
    v_rcp_f32 v31, v31
    v_pk_mul_f32 v[24:25], v[24:25], v[26:27]
    v_pk_mul_f32 v[28:29], v[28:29], v[30:31]
    v_cvt_pk_bf16_f32 v168, v24, v25
    v_cvt_pk_bf16_f32 v169, v28, v29
    v_cvt_pk_bf16_f32 v32, v116, v117
    v_cvt_pk_bf16_f32 v33, v118, v119
    v_lshlrev_b32 v24, 16, v32
    v_and_b32 v25, 0xffff0000, v32
    v_lshlrev_b32 v28, 16, v33
    v_and_b32 v29, 0xffff0000, v33
    v_pk_add_f32 v[24:25], v[24:25], v[84:85]
    v_pk_add_f32 v[28:29], v[28:29], v[86:87]
    v_cvt_pk_bf16_f32 v32, v24, v25
    v_cvt_pk_bf16_f32 v33, v28, v29
    v_lshlrev_b32 v24, 16, v32
    v_and_b32 v25, 0xffff0000, v32
    v_lshlrev_b32 v28, 16, v33
    v_and_b32 v29, 0xffff0000, v33
    v_pk_mul_f32 v[26:27], v[24:25], v[24:25]
    v_pk_mul_f32 v[30:31], v[28:29], v[28:29]
    v_pk_fma_f32 v[26:27], v[26:27], s[22:23], v[16:17]
    v_pk_fma_f32 v[30:31], v[30:31], s[22:23], v[16:17]
    v_pk_mul_f32 v[26:27], v[26:27], v[24:25]
    v_pk_mul_f32 v[30:31], v[30:31], v[28:29]
    v_exp_f32 v26, v26
    v_exp_f32 v27, v27
    v_exp_f32 v30, v30
    v_exp_f32 v31, v31
    v_pk_add_f32 v[26:27], v[26:27], v[18:19]
    v_pk_add_f32 v[30:31], v[30:31], v[18:19]
    v_rcp_f32 v26, v26
    v_rcp_f32 v27, v27
    v_rcp_f32 v30, v30
    v_rcp_f32 v31, v31
    v_pk_mul_f32 v[24:25], v[24:25], v[26:27]
    v_pk_mul_f32 v[28:29], v[28:29], v[30:31]
    v_cvt_pk_bf16_f32 v170, v24, v25
    v_cvt_pk_bf16_f32 v171, v28, v29
    s_nop 1
    v_permlane32_swap_b32 v168, v170
    v_permlane32_swap_b32 v169, v171
    buffer_store_dwordx4 v[168:171], v20, s[8:11], s26 offen offset:2048 sc1
    v_cvt_pk_bf16_f32 v32, v120, v121
    v_cvt_pk_bf16_f32 v33, v122, v123
    v_lshlrev_b32 v24, 16, v32
    v_and_b32 v25, 0xffff0000, v32
    v_lshlrev_b32 v28, 16, v33
    v_and_b32 v29, 0xffff0000, v33
    v_pk_add_f32 v[24:25], v[24:25], v[88:89]
    v_pk_add_f32 v[28:29], v[28:29], v[90:91]
    v_cvt_pk_bf16_f32 v32, v24, v25
    v_cvt_pk_bf16_f32 v33, v28, v29
    v_lshlrev_b32 v24, 16, v32
    v_and_b32 v25, 0xffff0000, v32
    v_lshlrev_b32 v28, 16, v33
    v_and_b32 v29, 0xffff0000, v33
    v_pk_mul_f32 v[26:27], v[24:25], v[24:25]
    v_pk_mul_f32 v[30:31], v[28:29], v[28:29]
    v_pk_fma_f32 v[26:27], v[26:27], s[22:23], v[16:17]
    v_pk_fma_f32 v[30:31], v[30:31], s[22:23], v[16:17]
    v_pk_mul_f32 v[26:27], v[26:27], v[24:25]
    v_pk_mul_f32 v[30:31], v[30:31], v[28:29]
    v_exp_f32 v26, v26
    v_exp_f32 v27, v27
    v_exp_f32 v30, v30
    v_exp_f32 v31, v31
    v_pk_add_f32 v[26:27], v[26:27], v[18:19]
    v_pk_add_f32 v[30:31], v[30:31], v[18:19]
    v_rcp_f32 v26, v26
    v_rcp_f32 v27, v27
    v_rcp_f32 v30, v30
    v_rcp_f32 v31, v31
    v_pk_mul_f32 v[24:25], v[24:25], v[26:27]
    v_pk_mul_f32 v[28:29], v[28:29], v[30:31]
    v_cvt_pk_bf16_f32 v172, v24, v25
    v_cvt_pk_bf16_f32 v173, v28, v29
    v_cvt_pk_bf16_f32 v32, v124, v125
    v_cvt_pk_bf16_f32 v33, v126, v127
    v_lshlrev_b32 v24, 16, v32
    v_and_b32 v25, 0xffff0000, v32
    v_lshlrev_b32 v28, 16, v33
    v_and_b32 v29, 0xffff0000, v33
    v_pk_add_f32 v[24:25], v[24:25], v[92:93]
    v_pk_add_f32 v[28:29], v[28:29], v[94:95]
    v_cvt_pk_bf16_f32 v32, v24, v25
    v_cvt_pk_bf16_f32 v33, v28, v29
    v_lshlrev_b32 v24, 16, v32
    v_and_b32 v25, 0xffff0000, v32
    v_lshlrev_b32 v28, 16, v33
    v_and_b32 v29, 0xffff0000, v33
    v_pk_mul_f32 v[26:27], v[24:25], v[24:25]
    v_pk_mul_f32 v[30:31], v[28:29], v[28:29]
    v_pk_fma_f32 v[26:27], v[26:27], s[22:23], v[16:17]
    v_pk_fma_f32 v[30:31], v[30:31], s[22:23], v[16:17]
    v_pk_mul_f32 v[26:27], v[26:27], v[24:25]
    v_pk_mul_f32 v[30:31], v[30:31], v[28:29]
    v_exp_f32 v26, v26
    v_exp_f32 v27, v27
    v_exp_f32 v30, v30
    v_exp_f32 v31, v31
    v_pk_add_f32 v[26:27], v[26:27], v[18:19]
    v_pk_add_f32 v[30:31], v[30:31], v[18:19]
    v_rcp_f32 v26, v26
    v_rcp_f32 v27, v27
    v_rcp_f32 v30, v30
    v_rcp_f32 v31, v31
    v_pk_mul_f32 v[24:25], v[24:25], v[26:27]
    v_pk_mul_f32 v[28:29], v[28:29], v[30:31]
    v_cvt_pk_bf16_f32 v174, v24, v25
    v_cvt_pk_bf16_f32 v175, v28, v29
    s_nop 1
    v_permlane32_swap_b32 v172, v174
    v_permlane32_swap_b32 v173, v175
    buffer_store_dwordx4 v[172:175], v20, s[8:11], s26 offen offset:3072 sc1
    v_cvt_pk_bf16_f32 v32, v128, v129
    v_cvt_pk_bf16_f32 v33, v130, v131
    v_lshlrev_b32 v24, 16, v32
    v_and_b32 v25, 0xffff0000, v32
    v_lshlrev_b32 v28, 16, v33
    v_and_b32 v29, 0xffff0000, v33
    v_pk_add_f32 v[24:25], v[24:25], v[64:65]
    v_pk_add_f32 v[28:29], v[28:29], v[66:67]
    v_cvt_pk_bf16_f32 v32, v24, v25
    v_cvt_pk_bf16_f32 v33, v28, v29
    v_lshlrev_b32 v24, 16, v32
    v_and_b32 v25, 0xffff0000, v32
    v_lshlrev_b32 v28, 16, v33
    v_and_b32 v29, 0xffff0000, v33
    v_pk_mul_f32 v[26:27], v[24:25], v[24:25]
    v_pk_mul_f32 v[30:31], v[28:29], v[28:29]
    v_pk_fma_f32 v[26:27], v[26:27], s[22:23], v[16:17]
    v_pk_fma_f32 v[30:31], v[30:31], s[22:23], v[16:17]
    v_pk_mul_f32 v[26:27], v[26:27], v[24:25]
    v_pk_mul_f32 v[30:31], v[30:31], v[28:29]
    v_exp_f32 v26, v26
    v_exp_f32 v27, v27
    v_exp_f32 v30, v30
    v_exp_f32 v31, v31
    v_pk_add_f32 v[26:27], v[26:27], v[18:19]
    v_pk_add_f32 v[30:31], v[30:31], v[18:19]
    v_rcp_f32 v26, v26
    v_rcp_f32 v27, v27
    v_rcp_f32 v30, v30
    v_rcp_f32 v31, v31
    v_pk_mul_f32 v[24:25], v[24:25], v[26:27]
    v_pk_mul_f32 v[28:29], v[28:29], v[30:31]
    v_cvt_pk_bf16_f32 v176, v24, v25
    v_cvt_pk_bf16_f32 v177, v28, v29
    v_cvt_pk_bf16_f32 v32, v132, v133
    v_cvt_pk_bf16_f32 v33, v134, v135
    v_lshlrev_b32 v24, 16, v32
    v_and_b32 v25, 0xffff0000, v32
    v_lshlrev_b32 v28, 16, v33
    v_and_b32 v29, 0xffff0000, v33
    v_pk_add_f32 v[24:25], v[24:25], v[68:69]
    v_pk_add_f32 v[28:29], v[28:29], v[70:71]
    v_cvt_pk_bf16_f32 v32, v24, v25
    v_cvt_pk_bf16_f32 v33, v28, v29
    v_lshlrev_b32 v24, 16, v32
    v_and_b32 v25, 0xffff0000, v32
    v_lshlrev_b32 v28, 16, v33
    v_and_b32 v29, 0xffff0000, v33
    v_pk_mul_f32 v[26:27], v[24:25], v[24:25]
    v_pk_mul_f32 v[30:31], v[28:29], v[28:29]
    v_pk_fma_f32 v[26:27], v[26:27], s[22:23], v[16:17]
    v_pk_fma_f32 v[30:31], v[30:31], s[22:23], v[16:17]
    v_pk_mul_f32 v[26:27], v[26:27], v[24:25]
    v_pk_mul_f32 v[30:31], v[30:31], v[28:29]
    v_exp_f32 v26, v26
    v_exp_f32 v27, v27
    v_exp_f32 v30, v30
    v_exp_f32 v31, v31
    v_pk_add_f32 v[26:27], v[26:27], v[18:19]
    v_pk_add_f32 v[30:31], v[30:31], v[18:19]
    v_rcp_f32 v26, v26
    v_rcp_f32 v27, v27
    v_rcp_f32 v30, v30
    v_rcp_f32 v31, v31
    v_pk_mul_f32 v[24:25], v[24:25], v[26:27]
    v_pk_mul_f32 v[28:29], v[28:29], v[30:31]
    v_cvt_pk_bf16_f32 v178, v24, v25
    v_cvt_pk_bf16_f32 v179, v28, v29
    s_nop 1
    v_permlane32_swap_b32 v176, v178
    v_permlane32_swap_b32 v177, v179
    buffer_store_dwordx4 v[176:179], v20, s[8:11], s27 offen offset:0 sc1
    v_cvt_pk_bf16_f32 v32, v136, v137
    v_cvt_pk_bf16_f32 v33, v138, v139
    v_lshlrev_b32 v24, 16, v32
    v_and_b32 v25, 0xffff0000, v32
    v_lshlrev_b32 v28, 16, v33
    v_and_b32 v29, 0xffff0000, v33
    v_pk_add_f32 v[24:25], v[24:25], v[72:73]
    v_pk_add_f32 v[28:29], v[28:29], v[74:75]
    v_cvt_pk_bf16_f32 v32, v24, v25
    v_cvt_pk_bf16_f32 v33, v28, v29
    v_lshlrev_b32 v24, 16, v32
    v_and_b32 v25, 0xffff0000, v32
    v_lshlrev_b32 v28, 16, v33
    v_and_b32 v29, 0xffff0000, v33
    v_pk_mul_f32 v[26:27], v[24:25], v[24:25]
    v_pk_mul_f32 v[30:31], v[28:29], v[28:29]
    v_pk_fma_f32 v[26:27], v[26:27], s[22:23], v[16:17]
    v_pk_fma_f32 v[30:31], v[30:31], s[22:23], v[16:17]
    v_pk_mul_f32 v[26:27], v[26:27], v[24:25]
    v_pk_mul_f32 v[30:31], v[30:31], v[28:29]
    v_exp_f32 v26, v26
    v_exp_f32 v27, v27
    v_exp_f32 v30, v30
    v_exp_f32 v31, v31
    v_pk_add_f32 v[26:27], v[26:27], v[18:19]
    v_pk_add_f32 v[30:31], v[30:31], v[18:19]
    v_rcp_f32 v26, v26
    v_rcp_f32 v27, v27
    v_rcp_f32 v30, v30
    v_rcp_f32 v31, v31
    v_pk_mul_f32 v[24:25], v[24:25], v[26:27]
    v_pk_mul_f32 v[28:29], v[28:29], v[30:31]
    v_cvt_pk_bf16_f32 v180, v24, v25
    v_cvt_pk_bf16_f32 v181, v28, v29
    v_cvt_pk_bf16_f32 v32, v140, v141
    v_cvt_pk_bf16_f32 v33, v142, v143
    v_lshlrev_b32 v24, 16, v32
    v_and_b32 v25, 0xffff0000, v32
    v_lshlrev_b32 v28, 16, v33
    v_and_b32 v29, 0xffff0000, v33
    v_pk_add_f32 v[24:25], v[24:25], v[76:77]
    v_pk_add_f32 v[28:29], v[28:29], v[78:79]
    v_cvt_pk_bf16_f32 v32, v24, v25
    v_cvt_pk_bf16_f32 v33, v28, v29
    v_lshlrev_b32 v24, 16, v32
    v_and_b32 v25, 0xffff0000, v32
    v_lshlrev_b32 v28, 16, v33
    v_and_b32 v29, 0xffff0000, v33
    v_pk_mul_f32 v[26:27], v[24:25], v[24:25]
    v_pk_mul_f32 v[30:31], v[28:29], v[28:29]
    v_pk_fma_f32 v[26:27], v[26:27], s[22:23], v[16:17]
    v_pk_fma_f32 v[30:31], v[30:31], s[22:23], v[16:17]
    v_pk_mul_f32 v[26:27], v[26:27], v[24:25]
    v_pk_mul_f32 v[30:31], v[30:31], v[28:29]
    v_exp_f32 v26, v26
    v_exp_f32 v27, v27
    v_exp_f32 v30, v30
    v_exp_f32 v31, v31
    v_pk_add_f32 v[26:27], v[26:27], v[18:19]
    v_pk_add_f32 v[30:31], v[30:31], v[18:19]
    v_rcp_f32 v26, v26
    v_rcp_f32 v27, v27
    v_rcp_f32 v30, v30
    v_rcp_f32 v31, v31
    v_pk_mul_f32 v[24:25], v[24:25], v[26:27]
    v_pk_mul_f32 v[28:29], v[28:29], v[30:31]
    v_cvt_pk_bf16_f32 v182, v24, v25
    v_cvt_pk_bf16_f32 v183, v28, v29
    s_nop 1
    v_permlane32_swap_b32 v180, v182
    v_permlane32_swap_b32 v181, v183
    buffer_store_dwordx4 v[180:183], v20, s[8:11], s27 offen offset:1024 sc1
    v_cvt_pk_bf16_f32 v32, v144, v145
    v_cvt_pk_bf16_f32 v33, v146, v147
    v_lshlrev_b32 v24, 16, v32
    v_and_b32 v25, 0xffff0000, v32
    v_lshlrev_b32 v28, 16, v33
    v_and_b32 v29, 0xffff0000, v33
    v_pk_add_f32 v[24:25], v[24:25], v[80:81]
    v_pk_add_f32 v[28:29], v[28:29], v[82:83]
    v_cvt_pk_bf16_f32 v32, v24, v25
    v_cvt_pk_bf16_f32 v33, v28, v29
    v_lshlrev_b32 v24, 16, v32
    v_and_b32 v25, 0xffff0000, v32
    v_lshlrev_b32 v28, 16, v33
    v_and_b32 v29, 0xffff0000, v33
    v_pk_mul_f32 v[26:27], v[24:25], v[24:25]
    v_pk_mul_f32 v[30:31], v[28:29], v[28:29]
    v_pk_fma_f32 v[26:27], v[26:27], s[22:23], v[16:17]
    v_pk_fma_f32 v[30:31], v[30:31], s[22:23], v[16:17]
    v_pk_mul_f32 v[26:27], v[26:27], v[24:25]
    v_pk_mul_f32 v[30:31], v[30:31], v[28:29]
    v_exp_f32 v26, v26
    v_exp_f32 v27, v27
    v_exp_f32 v30, v30
    v_exp_f32 v31, v31
    v_pk_add_f32 v[26:27], v[26:27], v[18:19]
    v_pk_add_f32 v[30:31], v[30:31], v[18:19]
    v_rcp_f32 v26, v26
    v_rcp_f32 v27, v27
    v_rcp_f32 v30, v30
    v_rcp_f32 v31, v31
    v_pk_mul_f32 v[24:25], v[24:25], v[26:27]
    v_pk_mul_f32 v[28:29], v[28:29], v[30:31]
    v_cvt_pk_bf16_f32 v184, v24, v25
    v_cvt_pk_bf16_f32 v185, v28, v29
    v_cvt_pk_bf16_f32 v32, v148, v149
    v_cvt_pk_bf16_f32 v33, v150, v151
    v_lshlrev_b32 v24, 16, v32
    v_and_b32 v25, 0xffff0000, v32
    v_lshlrev_b32 v28, 16, v33
    v_and_b32 v29, 0xffff0000, v33
    v_pk_add_f32 v[24:25], v[24:25], v[84:85]
    v_pk_add_f32 v[28:29], v[28:29], v[86:87]
    v_cvt_pk_bf16_f32 v32, v24, v25
    v_cvt_pk_bf16_f32 v33, v28, v29
    v_lshlrev_b32 v24, 16, v32
    v_and_b32 v25, 0xffff0000, v32
    v_lshlrev_b32 v28, 16, v33
    v_and_b32 v29, 0xffff0000, v33
    v_pk_mul_f32 v[26:27], v[24:25], v[24:25]
    v_pk_mul_f32 v[30:31], v[28:29], v[28:29]
    v_pk_fma_f32 v[26:27], v[26:27], s[22:23], v[16:17]
    v_pk_fma_f32 v[30:31], v[30:31], s[22:23], v[16:17]
    v_pk_mul_f32 v[26:27], v[26:27], v[24:25]
    v_pk_mul_f32 v[30:31], v[30:31], v[28:29]
    v_exp_f32 v26, v26
    v_exp_f32 v27, v27
    v_exp_f32 v30, v30
    v_exp_f32 v31, v31
    v_pk_add_f32 v[26:27], v[26:27], v[18:19]
    v_pk_add_f32 v[30:31], v[30:31], v[18:19]
    v_rcp_f32 v26, v26
    v_rcp_f32 v27, v27
    v_rcp_f32 v30, v30
    v_rcp_f32 v31, v31
    v_pk_mul_f32 v[24:25], v[24:25], v[26:27]
    v_pk_mul_f32 v[28:29], v[28:29], v[30:31]
    v_cvt_pk_bf16_f32 v186, v24, v25
    v_cvt_pk_bf16_f32 v187, v28, v29
    s_nop 1
    v_permlane32_swap_b32 v184, v186
    v_permlane32_swap_b32 v185, v187
    buffer_store_dwordx4 v[184:187], v20, s[8:11], s27 offen offset:2048 sc1
    v_cvt_pk_bf16_f32 v32, v152, v153
    v_cvt_pk_bf16_f32 v33, v154, v155
    v_lshlrev_b32 v24, 16, v32
    v_and_b32 v25, 0xffff0000, v32
    v_lshlrev_b32 v28, 16, v33
    v_and_b32 v29, 0xffff0000, v33
    v_pk_add_f32 v[24:25], v[24:25], v[88:89]
    v_pk_add_f32 v[28:29], v[28:29], v[90:91]
    v_cvt_pk_bf16_f32 v32, v24, v25
    v_cvt_pk_bf16_f32 v33, v28, v29
    v_lshlrev_b32 v24, 16, v32
    v_and_b32 v25, 0xffff0000, v32
    v_lshlrev_b32 v28, 16, v33
    v_and_b32 v29, 0xffff0000, v33
    v_pk_mul_f32 v[26:27], v[24:25], v[24:25]
    v_pk_mul_f32 v[30:31], v[28:29], v[28:29]
    v_pk_fma_f32 v[26:27], v[26:27], s[22:23], v[16:17]
    v_pk_fma_f32 v[30:31], v[30:31], s[22:23], v[16:17]
    v_pk_mul_f32 v[26:27], v[26:27], v[24:25]
    v_pk_mul_f32 v[30:31], v[30:31], v[28:29]
    v_exp_f32 v26, v26
    v_exp_f32 v27, v27
    v_exp_f32 v30, v30
    v_exp_f32 v31, v31
    v_pk_add_f32 v[26:27], v[26:27], v[18:19]
    v_pk_add_f32 v[30:31], v[30:31], v[18:19]
    v_rcp_f32 v26, v26
    v_rcp_f32 v27, v27
    v_rcp_f32 v30, v30
    v_rcp_f32 v31, v31
    v_pk_mul_f32 v[24:25], v[24:25], v[26:27]
    v_pk_mul_f32 v[28:29], v[28:29], v[30:31]
    v_cvt_pk_bf16_f32 v188, v24, v25
    v_cvt_pk_bf16_f32 v189, v28, v29
    v_cvt_pk_bf16_f32 v32, v156, v157
    v_cvt_pk_bf16_f32 v33, v158, v159
    v_lshlrev_b32 v24, 16, v32
    v_and_b32 v25, 0xffff0000, v32
    v_lshlrev_b32 v28, 16, v33
    v_and_b32 v29, 0xffff0000, v33
    v_pk_add_f32 v[24:25], v[24:25], v[92:93]
    v_pk_add_f32 v[28:29], v[28:29], v[94:95]
    v_cvt_pk_bf16_f32 v32, v24, v25
    v_cvt_pk_bf16_f32 v33, v28, v29
    v_lshlrev_b32 v24, 16, v32
    v_and_b32 v25, 0xffff0000, v32
    v_lshlrev_b32 v28, 16, v33
    v_and_b32 v29, 0xffff0000, v33
    v_pk_mul_f32 v[26:27], v[24:25], v[24:25]
    v_pk_mul_f32 v[30:31], v[28:29], v[28:29]
    v_pk_fma_f32 v[26:27], v[26:27], s[22:23], v[16:17]
    v_pk_fma_f32 v[30:31], v[30:31], s[22:23], v[16:17]
    v_pk_mul_f32 v[26:27], v[26:27], v[24:25]
    v_pk_mul_f32 v[30:31], v[30:31], v[28:29]
    v_exp_f32 v26, v26
    v_exp_f32 v27, v27
    v_exp_f32 v30, v30
    v_exp_f32 v31, v31
    v_pk_add_f32 v[26:27], v[26:27], v[18:19]
    v_pk_add_f32 v[30:31], v[30:31], v[18:19]
    v_rcp_f32 v26, v26
    v_rcp_f32 v27, v27
    v_rcp_f32 v30, v30
    v_rcp_f32 v31, v31
    v_pk_mul_f32 v[24:25], v[24:25], v[26:27]
    v_pk_mul_f32 v[28:29], v[28:29], v[30:31]
    v_cvt_pk_bf16_f32 v190, v24, v25
    v_cvt_pk_bf16_f32 v191, v28, v29
    s_nop 1
    v_permlane32_swap_b32 v188, v190
    v_permlane32_swap_b32 v189, v191
    buffer_store_dwordx4 v[188:191], v20, s[8:11], s27 offen offset:3072 sc1
    s_waitcnt vmcnt(0)
    s_barrier
    s_cmp_lg_u32 s28, 0
    s_cbranch_scc1 G_sig
    s_lshl_b32 s20, s4, 7
    s_add_u32 s20, s20, 25100288
    v_mov_b32 v1, s20
    v_mov_b32 v2, 1
    s_mov_b64 exec, 1
    buffer_atomic_add v2, v1, s[8:11], 0 offen
    s_mov_b64 exec, -1
G_sig:
    s_branch F_entry
A_p2:
    s_waitcnt vmcnt(1)
    v_lshlrev_b32 v64, 16, v16
    v_and_b32 v65, 0xffff0000, v16
    v_lshlrev_b32 v66, 16, v17
    v_and_b32 v67, 0xffff0000, v17
    v_lshlrev_b32 v68, 16, v18
    v_and_b32 v69, 0xffff0000, v18
    v_lshlrev_b32 v70, 16, v19
    v_and_b32 v71, 0xffff0000, v19
    v_lshlrev_b32 v72, 16, v20
    v_and_b32 v73, 0xffff0000, v20
    v_lshlrev_b32 v74, 16, v21
    v_and_b32 v75, 0xffff0000, v21
    v_lshlrev_b32 v76, 16, v22
    v_and_b32 v77, 0xffff0000, v22
    v_lshlrev_b32 v78, 16, v23
    v_and_b32 v79, 0xffff0000, v23
    v_add_f32 v4, v64, v65
    v_add_f32 v5, v66, v67
    v_add_f32 v6, v68, v69
    v_add_f32 v7, v70, v71
    v_add_f32 v4, v4, v6
    v_add_f32 v5, v5, v7
    v_add_f32 v6, v72, v73
    v_add_f32 v7, v74, v75
    v_add_f32 v4, v4, v6
    v_add_f32 v5, v5, v7
    v_add_f32 v6, v76, v77
    v_add_f32 v7, v78, v79
    v_add_f32 v4, v4, v6
    v_add_f32 v5, v5, v7
    v_add_f32 v4, v4, v5
    s_nop 1
    v_add_f32 v4, v4, v4 quad_perm:[1,0,3,2] row_mask:0xf bank_mask:0xf
    s_nop 1
    v_add_f32 v4, v4, v4 quad_perm:[2,3,0,1] row_mask:0xf bank_mask:0xf
    s_nop 1
    v_add_f32 v4, v4, v4 row_half_mirror row_mask:0xf bank_mask:0xf
    s_nop 1
    v_add_f32 v4, v4, v4 row_mirror row_mask:0xf bank_mask:0xf
    ds_swizzle_b32 v5, v4 offset:0x401F
    s_waitcnt lgkmcnt(0)
    v_add_f32 v4, v4, v5
    v_mul_f32 v4, 0x3b000000, v4
    v_sub_f32 v5, v64, v4
    v_sub_f32 v7, v65, v4
    v_mul_f32 v6, v5, v5
    v_mul_f32 v8, v7, v7
    v_sub_f32 v5, v66, v4
    v_sub_f32 v7, v67, v4
    v_fmac_f32 v6, v5, v5
    v_fmac_f32 v8, v7, v7
    v_sub_f32 v5, v68, v4
    v_sub_f32 v7, v69, v4
    v_fmac_f32 v6, v5, v5
    v_fmac_f32 v8, v7, v7
    v_sub_f32 v5, v70, v4
    v_sub_f32 v7, v71, v4
    v_fmac_f32 v6, v5, v5
    v_fmac_f32 v8, v7, v7
    v_sub_f32 v5, v72, v4
    v_sub_f32 v7, v73, v4
    v_fmac_f32 v6, v5, v5
    v_fmac_f32 v8, v7, v7
    v_sub_f32 v5, v74, v4
    v_sub_f32 v7, v75, v4
    v_fmac_f32 v6, v5, v5
    v_fmac_f32 v8, v7, v7
    v_sub_f32 v5, v76, v4
    v_sub_f32 v7, v77, v4
    v_fmac_f32 v6, v5, v5
    v_fmac_f32 v8, v7, v7
    v_sub_f32 v5, v78, v4
    v_sub_f32 v7, v79, v4
    v_fmac_f32 v6, v5, v5
    v_fmac_f32 v8, v7, v7
    v_add_f32 v6, v6, v8
    s_nop 1
    v_add_f32 v6, v6, v6 quad_perm:[1,0,3,2] row_mask:0xf bank_mask:0xf
    s_nop 1
    v_add_f32 v6, v6, v6 quad_perm:[2,3,0,1] row_mask:0xf bank_mask:0xf
    s_nop 1
    v_add_f32 v6, v6, v6 row_half_mirror row_mask:0xf bank_mask:0xf
    s_nop 1
    v_add_f32 v6, v6, v6 row_mirror row_mask:0xf bank_mask:0xf
    ds_swizzle_b32 v5, v6 offset:0x401F
    s_waitcnt lgkmcnt(0)
    v_add_f32 v6, v6, v5
    v_mul_f32 v6, 0x3b000000, v6
    v_cvt_pk_bf16_f32 v4, v4, v4
    v_lshlrev_b32 v4, 16, v4
    v_cvt_pk_bf16_f32 v6, v6, v6
    v_lshlrev_b32 v6, 16, v6
    v_add_f32 v6, 0x3727c5ac, v6
    v_cvt_pk_bf16_f32 v6, v6, v6
    v_lshlrev_b32 v6, 16, v6
    v_sqrt_f32 v6, v6
    s_nop 1
    v_cvt_pk_bf16_f32 v6, v6, v6
    v_lshlrev_b32 v6, 16, v6
    v_rcp_f32 v7, v6
    s_nop 1
    v_sub_f32 v64, v64, v4
    v_sub_f32 v65, v65, v4
    v_cvt_pk_bf16_f32 v8, v64, v65
    v_lshlrev_b32 v64, 16, v8
    v_and_b32 v65, 0xffff0000, v8
    v_mul_f32 v8, v64, v7
    v_mul_f32 v9, v65, v7
    v_fma_f32 v64, -v8, v6, v64
    v_fma_f32 v65, -v9, v6, v65
    v_fma_f32 v8, v64, v7, v8
    v_fma_f32 v9, v65, v7, v9
    v_cvt_pk_bf16_f32 v16, v8, v9
    v_sub_f32 v66, v66, v4
    v_sub_f32 v67, v67, v4
    v_cvt_pk_bf16_f32 v8, v66, v67
    v_lshlrev_b32 v66, 16, v8
    v_and_b32 v67, 0xffff0000, v8
    v_mul_f32 v8, v66, v7
    v_mul_f32 v9, v67, v7
    v_fma_f32 v66, -v8, v6, v66
    v_fma_f32 v67, -v9, v6, v67
    v_fma_f32 v8, v66, v7, v8
    v_fma_f32 v9, v67, v7, v9
    v_cvt_pk_bf16_f32 v17, v8, v9
    v_sub_f32 v68, v68, v4
    v_sub_f32 v69, v69, v4
    v_cvt_pk_bf16_f32 v8, v68, v69
    v_lshlrev_b32 v68, 16, v8
    v_and_b32 v69, 0xffff0000, v8
    v_mul_f32 v8, v68, v7
    v_mul_f32 v9, v69, v7
    v_fma_f32 v68, -v8, v6, v68
    v_fma_f32 v69, -v9, v6, v69
    v_fma_f32 v8, v68, v7, v8
    v_fma_f32 v9, v69, v7, v9
    v_cvt_pk_bf16_f32 v18, v8, v9
    v_sub_f32 v70, v70, v4
    v_sub_f32 v71, v71, v4
    v_cvt_pk_bf16_f32 v8, v70, v71
    v_lshlrev_b32 v70, 16, v8
    v_and_b32 v71, 0xffff0000, v8
    v_mul_f32 v8, v70, v7
    v_mul_f32 v9, v71, v7
    v_fma_f32 v70, -v8, v6, v70
    v_fma_f32 v71, -v9, v6, v71
    v_fma_f32 v8, v70, v7, v8
    v_fma_f32 v9, v71, v7, v9
    v_cvt_pk_bf16_f32 v19, v8, v9
    v_sub_f32 v72, v72, v4
    v_sub_f32 v73, v73, v4
    v_cvt_pk_bf16_f32 v8, v72, v73
    v_lshlrev_b32 v72, 16, v8
    v_and_b32 v73, 0xffff0000, v8
    v_mul_f32 v8, v72, v7
    v_mul_f32 v9, v73, v7
    v_fma_f32 v72, -v8, v6, v72
    v_fma_f32 v73, -v9, v6, v73
    v_fma_f32 v8, v72, v7, v8
    v_fma_f32 v9, v73, v7, v9
    v_cvt_pk_bf16_f32 v20, v8, v9
    v_sub_f32 v74, v74, v4
    v_sub_f32 v75, v75, v4
    v_cvt_pk_bf16_f32 v8, v74, v75
    v_lshlrev_b32 v74, 16, v8
    v_and_b32 v75, 0xffff0000, v8
    v_mul_f32 v8, v74, v7
    v_mul_f32 v9, v75, v7
    v_fma_f32 v74, -v8, v6, v74
    v_fma_f32 v75, -v9, v6, v75
    v_fma_f32 v8, v74, v7, v8
    v_fma_f32 v9, v75, v7, v9
    v_cvt_pk_bf16_f32 v21, v8, v9
    v_sub_f32 v76, v76, v4
    v_sub_f32 v77, v77, v4
    v_cvt_pk_bf16_f32 v8, v76, v77
    v_lshlrev_b32 v76, 16, v8
    v_and_b32 v77, 0xffff0000, v8
    v_mul_f32 v8, v76, v7
    v_mul_f32 v9, v77, v7
    v_fma_f32 v76, -v8, v6, v76
    v_fma_f32 v77, -v9, v6, v77
    v_fma_f32 v8, v76, v7, v8
    v_fma_f32 v9, v77, v7, v9
    v_cvt_pk_bf16_f32 v22, v8, v9
    v_sub_f32 v78, v78, v4
    v_sub_f32 v79, v79, v4
    v_cvt_pk_bf16_f32 v8, v78, v79
    v_lshlrev_b32 v78, 16, v8
    v_and_b32 v79, 0xffff0000, v8
    v_mul_f32 v8, v78, v7
    v_mul_f32 v9, v79, v7
    v_fma_f32 v78, -v8, v6, v78
    v_fma_f32 v79, -v9, v6, v79
    v_fma_f32 v8, v78, v7, v8
    v_fma_f32 v9, v79, v7, v9
    v_cvt_pk_bf16_f32 v23, v8, v9
    v_lshrrev_b32 v12, 1, v2
    v_lshlrev_b32 v12, 10, v12
    v_and_b32 v13, 1, v2
    v_lshl_add_u32 v12, v13, 9, v12
    v_lshl_add_u32 v12, v1, 4, v12
    s_lshr_b32 s12, s2, 2
    s_lshl_b32 s12, s12, 15
    s_and_b32 s13, s2, 3
    s_lshl_b32 s13, s13, 7
    s_add_u32 s12, s12, s13
    s_add_u32 s12, s12, 0
    s_add_u32 s13, s12, 16384
    buffer_store_dwordx4 v[16:19], v12, s[8:11], s12 offen sc1
    buffer_store_dwordx4 v[20:23], v12, s[8:11], s13 offen sc1
    s_lshr_b32 s64, s2, 4
    s_add_u32 s64, s64, 24
    v_mov_b32 v61, 0
    buffer_load_dword v60, v61, s[84:87], 0 offen sc1
    s_waitcnt vmcnt(0)
    s_barrier
    s_cmp_lg_u32 s65, 0
    s_cbranch_scc1 A_ls
    v_readfirstlane_b32 s66, v60
    s_cmp_lg_u32 s66, 0
    s_cbranch_scc1 A_ls_ic_done
    v_mov_b32 v4, 0
    s_mov_b32 s46, 0
A_ls_ic:
    buffer_load_dword v5, v4, s[84:87], 0 offen sc1
    s_waitcnt vmcnt(0)
    v_readfirstlane_b32 s45, v5
    s_cmp_lg_u32 s45, 0
    s_cbranch_scc1 A_ls_ic_ok
    s_add_u32 s46, s46, 1
    s_cmp_ge_u32 s46, 0x20000
    s_cbranch_scc1 A_ls_ic_ok
    s_sleep 2
    s_branch A_ls_ic
A_ls_ic_ok:
    s_mov_b32 s66, 1
A_ls_ic_done:
    s_lshl_b32 s20, s64, 7
    s_add_u32 s20, s20, 25100288
    v_mov_b32 v1, s20
    v_mov_b32 v2, 1
    s_mov_b64 exec, 1
    buffer_atomic_add v2, v1, s[8:11], 0 offen
    s_mov_b64 exec, -1
A_ls:
    s_mov_b32 s12, s56
    s_and_b32 s13, s57, 0xffff
    s_mov_b32 s14, 1835008
    s_mov_b32 s15, 0x00020000
    s_mov_b32 s20, 1024
    s_sub_u32 s3, s2, 224
    s_lshr_b32 s5, s3, 1
    s_and_b32 s6, s3, 1
    s_mul_i32 s6, s6, 56
    s_mul_i32 s7, s65, 14
    s_add_u32 s6, s6, s7
    s_mul_i32 s7, s5, 112
    s_add_u32 s7, s7, s6
    s_lshl_b32 s7, s7, 10
    s_add_u32 s7, s7, 8912896
    s_lshr_b32 s64, s3, 3
    s_add_u32 s64, s64, 54
    v_and_b32 v28, 63, v0
    v_and_b32 v29, 31, v28
    v_lshrrev_b32 v30, 5, v28
    v_lshlrev_b32 v31, 4, v28
    s_lshl_b32 s21, s20, 3
    v_mul_lo_u32 v30, v30, s21
    v_lshl_add_u32 v30, v29, 1, v30
    s_lshl_b32 s5, s5, 6
    v_add_u32 v30, s5, v30
    s_lshl_b32 s6, s6, 4
    s_mul_i32 s6, s6, s20
    buffer_load_ushort v96, v30, s[12:15], s6 offen
    s_add_u32 s6, s6, s20
    buffer_load_ushort v97, v30, s[12:15], s6 offen
    s_add_u32 s6, s6, s20
    buffer_load_ushort v98, v30, s[12:15], s6 offen
    s_add_u32 s6, s6, s20
    buffer_load_ushort v99, v30, s[12:15], s6 offen
    s_add_u32 s6, s6, s20
    buffer_load_ushort v100, v30, s[12:15], s6 offen
    s_add_u32 s6, s6, s20
    buffer_load_ushort v101, v30, s[12:15], s6 offen
    s_add_u32 s6, s6, s20
    buffer_load_ushort v102, v30, s[12:15], s6 offen
    s_add_u32 s6, s6, s20
    buffer_load_ushort v103, v30, s[12:15], s6 offen
    s_add_u32 s6, s6, s20
    s_add_u32 s6, s6, s21
    buffer_load_ushort v104, v30, s[12:15], s6 offen
    s_add_u32 s6, s6, s20
    buffer_load_ushort v105, v30, s[12:15], s6 offen
    s_add_u32 s6, s6, s20
    buffer_load_ushort v106, v30, s[12:15], s6 offen
    s_add_u32 s6, s6, s20
    buffer_load_ushort v107, v30, s[12:15], s6 offen
    s_add_u32 s6, s6, s20
    buffer_load_ushort v108, v30, s[12:15], s6 offen
    s_add_u32 s6, s6, s20
    buffer_load_ushort v109, v30, s[12:15], s6 offen
    s_add_u32 s6, s6, s20
    buffer_load_ushort v110, v30, s[12:15], s6 offen
    s_add_u32 s6, s6, s20
    buffer_load_ushort v111, v30, s[12:15], s6 offen
    s_add_u32 s6, s6, s20
    s_add_u32 s6, s6, s21
    buffer_load_ushort v112, v30, s[12:15], s6 offen
    s_add_u32 s6, s6, s20
    buffer_load_ushort v113, v30, s[12:15], s6 offen
    s_add_u32 s6, s6, s20
    buffer_load_ushort v114, v30, s[12:15], s6 offen
    s_add_u32 s6, s6, s20
    buffer_load_ushort v115, v30, s[12:15], s6 offen
    s_add_u32 s6, s6, s20
    buffer_load_ushort v116, v30, s[12:15], s6 offen
    s_add_u32 s6, s6, s20
    buffer_load_ushort v117, v30, s[12:15], s6 offen
    s_add_u32 s6, s6, s20
    buffer_load_ushort v118, v30, s[12:15], s6 offen
    s_add_u32 s6, s6, s20
    buffer_load_ushort v119, v30, s[12:15], s6 offen
    s_add_u32 s6, s6, s20
    s_add_u32 s6, s6, s21
    buffer_load_ushort v120, v30, s[12:15], s6 offen
    s_add_u32 s6, s6, s20
    buffer_load_ushort v121, v30, s[12:15], s6 offen
    s_add_u32 s6, s6, s20
    buffer_load_ushort v122, v30, s[12:15], s6 offen
    s_add_u32 s6, s6, s20
    buffer_load_ushort v123, v30, s[12:15], s6 offen
    s_add_u32 s6, s6, s20
    buffer_load_ushort v124, v30, s[12:15], s6 offen
    s_add_u32 s6, s6, s20
    buffer_load_ushort v125, v30, s[12:15], s6 offen
    s_add_u32 s6, s6, s20
    buffer_load_ushort v126, v30, s[12:15], s6 offen
    s_add_u32 s6, s6, s20
    buffer_load_ushort v127, v30, s[12:15], s6 offen
    s_add_u32 s6, s6, s20
    s_add_u32 s6, s6, s21
    buffer_load_ushort v128, v30, s[12:15], s6 offen
    s_add_u32 s6, s6, s20
    buffer_load_ushort v129, v30, s[12:15], s6 offen
    s_add_u32 s6, s6, s20
    buffer_load_ushort v130, v30, s[12:15], s6 offen
    s_add_u32 s6, s6, s20
    buffer_load_ushort v131, v30, s[12:15], s6 offen
    s_add_u32 s6, s6, s20
    buffer_load_ushort v132, v30, s[12:15], s6 offen
    s_add_u32 s6, s6, s20
    buffer_load_ushort v133, v30, s[12:15], s6 offen
    s_add_u32 s6, s6, s20
    buffer_load_ushort v134, v30, s[12:15], s6 offen
    s_add_u32 s6, s6, s20
    buffer_load_ushort v135, v30, s[12:15], s6 offen
    s_add_u32 s6, s6, s20
    s_add_u32 s6, s6, s21
    buffer_load_ushort v136, v30, s[12:15], s6 offen
    s_add_u32 s6, s6, s20
    buffer_load_ushort v137, v30, s[12:15], s6 offen
    s_add_u32 s6, s6, s20
    buffer_load_ushort v138, v30, s[12:15], s6 offen
    s_add_u32 s6, s6, s20
    buffer_load_ushort v139, v30, s[12:15], s6 offen
    s_add_u32 s6, s6, s20
    buffer_load_ushort v140, v30, s[12:15], s6 offen
    s_add_u32 s6, s6, s20
    buffer_load_ushort v141, v30, s[12:15], s6 offen
    s_add_u32 s6, s6, s20
    buffer_load_ushort v142, v30, s[12:15], s6 offen
    s_add_u32 s6, s6, s20
    buffer_load_ushort v143, v30, s[12:15], s6 offen
    s_add_u32 s6, s6, s20
    s_add_u32 s6, s6, s21
    buffer_load_ushort v144, v30, s[12:15], s6 offen
    s_add_u32 s6, s6, s20
    buffer_load_ushort v145, v30, s[12:15], s6 offen
    s_add_u32 s6, s6, s20
    buffer_load_ushort v146, v30, s[12:15], s6 offen
    s_add_u32 s6, s6, s20
    buffer_load_ushort v147, v30, s[12:15], s6 offen
    s_add_u32 s6, s6, s20
    buffer_load_ushort v148, v30, s[12:15], s6 offen
    s_add_u32 s6, s6, s20
    buffer_load_ushort v149, v30, s[12:15], s6 offen
    s_add_u32 s6, s6, s20
    buffer_load_ushort v150, v30, s[12:15], s6 offen
    s_add_u32 s6, s6, s20
    buffer_load_ushort v151, v30, s[12:15], s6 offen
    s_add_u32 s6, s6, s20
    s_add_u32 s6, s6, s21
    s_waitcnt vmcnt(48)
    v_lshl_or_b32 v24, v97, 16, v96
    v_lshl_or_b32 v25, v99, 16, v98
    v_lshl_or_b32 v26, v101, 16, v100
    v_lshl_or_b32 v27, v103, 16, v102
    buffer_store_dwordx4 v[24:27], v31, s[8:11], s7 offen sc1
    s_add_u32 s7, s7, 1024
    s_waitcnt vmcnt(41)
    v_lshl_or_b32 v24, v105, 16, v104
    v_lshl_or_b32 v25, v107, 16, v106
    v_lshl_or_b32 v26, v109, 16, v108
    v_lshl_or_b32 v27, v111, 16, v110
    buffer_store_dwordx4 v[24:27], v31, s[8:11], s7 offen sc1
    s_add_u32 s7, s7, 1024
    s_waitcnt vmcnt(34)
    v_lshl_or_b32 v24, v113, 16, v112
    v_lshl_or_b32 v25, v115, 16, v114
    v_lshl_or_b32 v26, v117, 16, v116
    v_lshl_or_b32 v27, v119, 16, v118
    buffer_store_dwordx4 v[24:27], v31, s[8:11], s7 offen sc1
    s_add_u32 s7, s7, 1024
    s_waitcnt vmcnt(27)
    v_lshl_or_b32 v24, v121, 16, v120
    v_lshl_or_b32 v25, v123, 16, v122
    v_lshl_or_b32 v26, v125, 16, v124
    v_lshl_or_b32 v27, v127, 16, v126
    buffer_store_dwordx4 v[24:27], v31, s[8:11], s7 offen sc1
    s_add_u32 s7, s7, 1024
    s_waitcnt vmcnt(20)
    v_lshl_or_b32 v24, v129, 16, v128
    v_lshl_or_b32 v25, v131, 16, v130
    v_lshl_or_b32 v26, v133, 16, v132
    v_lshl_or_b32 v27, v135, 16, v134
    buffer_store_dwordx4 v[24:27], v31, s[8:11], s7 offen sc1
    s_add_u32 s7, s7, 1024
    s_waitcnt vmcnt(13)
    v_lshl_or_b32 v24, v137, 16, v136
    v_lshl_or_b32 v25, v139, 16, v138
    v_lshl_or_b32 v26, v141, 16, v140
    v_lshl_or_b32 v27, v143, 16, v142
    buffer_store_dwordx4 v[24:27], v31, s[8:11], s7 offen sc1
    s_add_u32 s7, s7, 1024
    s_waitcnt vmcnt(6)
    v_lshl_or_b32 v24, v145, 16, v144
    v_lshl_or_b32 v25, v147, 16, v146
    v_lshl_or_b32 v26, v149, 16, v148
    v_lshl_or_b32 v27, v151, 16, v150
    buffer_store_dwordx4 v[24:27], v31, s[8:11], s7 offen sc1
    s_add_u32 s7, s7, 1024
    buffer_load_ushort v96, v30, s[12:15], s6 offen
    s_add_u32 s6, s6, s20
    buffer_load_ushort v97, v30, s[12:15], s6 offen
    s_add_u32 s6, s6, s20
    buffer_load_ushort v98, v30, s[12:15], s6 offen
    s_add_u32 s6, s6, s20
    buffer_load_ushort v99, v30, s[12:15], s6 offen
    s_add_u32 s6, s6, s20
    buffer_load_ushort v100, v30, s[12:15], s6 offen
    s_add_u32 s6, s6, s20
    buffer_load_ushort v101, v30, s[12:15], s6 offen
    s_add_u32 s6, s6, s20
    buffer_load_ushort v102, v30, s[12:15], s6 offen
    s_add_u32 s6, s6, s20
    buffer_load_ushort v103, v30, s[12:15], s6 offen
    s_add_u32 s6, s6, s20
    s_add_u32 s6, s6, s21
    buffer_load_ushort v104, v30, s[12:15], s6 offen
    s_add_u32 s6, s6, s20
    buffer_load_ushort v105, v30, s[12:15], s6 offen
    s_add_u32 s6, s6, s20
    buffer_load_ushort v106, v30, s[12:15], s6 offen
    s_add_u32 s6, s6, s20
    buffer_load_ushort v107, v30, s[12:15], s6 offen
    s_add_u32 s6, s6, s20
    buffer_load_ushort v108, v30, s[12:15], s6 offen
    s_add_u32 s6, s6, s20
    buffer_load_ushort v109, v30, s[12:15], s6 offen
    s_add_u32 s6, s6, s20
    buffer_load_ushort v110, v30, s[12:15], s6 offen
    s_add_u32 s6, s6, s20
    buffer_load_ushort v111, v30, s[12:15], s6 offen
    s_add_u32 s6, s6, s20
    s_add_u32 s6, s6, s21
    buffer_load_ushort v112, v30, s[12:15], s6 offen
    s_add_u32 s6, s6, s20
    buffer_load_ushort v113, v30, s[12:15], s6 offen
    s_add_u32 s6, s6, s20
    buffer_load_ushort v114, v30, s[12:15], s6 offen
    s_add_u32 s6, s6, s20
    buffer_load_ushort v115, v30, s[12:15], s6 offen
    s_add_u32 s6, s6, s20
    buffer_load_ushort v116, v30, s[12:15], s6 offen
    s_add_u32 s6, s6, s20
    buffer_load_ushort v117, v30, s[12:15], s6 offen
    s_add_u32 s6, s6, s20
    buffer_load_ushort v118, v30, s[12:15], s6 offen
    s_add_u32 s6, s6, s20
    buffer_load_ushort v119, v30, s[12:15], s6 offen
    s_add_u32 s6, s6, s20
    s_add_u32 s6, s6, s21
    buffer_load_ushort v120, v30, s[12:15], s6 offen
    s_add_u32 s6, s6, s20
    buffer_load_ushort v121, v30, s[12:15], s6 offen
    s_add_u32 s6, s6, s20
    buffer_load_ushort v122, v30, s[12:15], s6 offen
    s_add_u32 s6, s6, s20
    buffer_load_ushort v123, v30, s[12:15], s6 offen
    s_add_u32 s6, s6, s20
    buffer_load_ushort v124, v30, s[12:15], s6 offen
    s_add_u32 s6, s6, s20
    buffer_load_ushort v125, v30, s[12:15], s6 offen
    s_add_u32 s6, s6, s20
    buffer_load_ushort v126, v30, s[12:15], s6 offen
    s_add_u32 s6, s6, s20
    buffer_load_ushort v127, v30, s[12:15], s6 offen
    s_add_u32 s6, s6, s20
    s_add_u32 s6, s6, s21
    buffer_load_ushort v128, v30, s[12:15], s6 offen
    s_add_u32 s6, s6, s20
    buffer_load_ushort v129, v30, s[12:15], s6 offen
    s_add_u32 s6, s6, s20
    buffer_load_ushort v130, v30, s[12:15], s6 offen
    s_add_u32 s6, s6, s20
    buffer_load_ushort v131, v30, s[12:15], s6 offen
    s_add_u32 s6, s6, s20
    buffer_load_ushort v132, v30, s[12:15], s6 offen
    s_add_u32 s6, s6, s20
    buffer_load_ushort v133, v30, s[12:15], s6 offen
    s_add_u32 s6, s6, s20
    buffer_load_ushort v134, v30, s[12:15], s6 offen
    s_add_u32 s6, s6, s20
    buffer_load_ushort v135, v30, s[12:15], s6 offen
    s_add_u32 s6, s6, s20
    s_add_u32 s6, s6, s21
    buffer_load_ushort v136, v30, s[12:15], s6 offen
    s_add_u32 s6, s6, s20
    buffer_load_ushort v137, v30, s[12:15], s6 offen
    s_add_u32 s6, s6, s20
    buffer_load_ushort v138, v30, s[12:15], s6 offen
    s_add_u32 s6, s6, s20
    buffer_load_ushort v139, v30, s[12:15], s6 offen
    s_add_u32 s6, s6, s20
    buffer_load_ushort v140, v30, s[12:15], s6 offen
    s_add_u32 s6, s6, s20
    buffer_load_ushort v141, v30, s[12:15], s6 offen
    s_add_u32 s6, s6, s20
    buffer_load_ushort v142, v30, s[12:15], s6 offen
    s_add_u32 s6, s6, s20
    buffer_load_ushort v143, v30, s[12:15], s6 offen
    s_add_u32 s6, s6, s20
    s_add_u32 s6, s6, s21
    buffer_load_ushort v144, v30, s[12:15], s6 offen
    s_add_u32 s6, s6, s20
    buffer_load_ushort v145, v30, s[12:15], s6 offen
    s_add_u32 s6, s6, s20
    buffer_load_ushort v146, v30, s[12:15], s6 offen
    s_add_u32 s6, s6, s20
    buffer_load_ushort v147, v30, s[12:15], s6 offen
    s_add_u32 s6, s6, s20
    buffer_load_ushort v148, v30, s[12:15], s6 offen
    s_add_u32 s6, s6, s20
    buffer_load_ushort v149, v30, s[12:15], s6 offen
    s_add_u32 s6, s6, s20
    buffer_load_ushort v150, v30, s[12:15], s6 offen
    s_add_u32 s6, s6, s20
    buffer_load_ushort v151, v30, s[12:15], s6 offen
    s_add_u32 s6, s6, s20
    s_add_u32 s6, s6, s21
    s_waitcnt vmcnt(48)
    v_lshl_or_b32 v24, v97, 16, v96
    v_lshl_or_b32 v25, v99, 16, v98
    v_lshl_or_b32 v26, v101, 16, v100
    v_lshl_or_b32 v27, v103, 16, v102
    buffer_store_dwordx4 v[24:27], v31, s[8:11], s7 offen sc1
    s_add_u32 s7, s7, 1024
    s_waitcnt vmcnt(41)
    v_lshl_or_b32 v24, v105, 16, v104
    v_lshl_or_b32 v25, v107, 16, v106
    v_lshl_or_b32 v26, v109, 16, v108
    v_lshl_or_b32 v27, v111, 16, v110
    buffer_store_dwordx4 v[24:27], v31, s[8:11], s7 offen sc1
    s_add_u32 s7, s7, 1024
    s_waitcnt vmcnt(34)
    v_lshl_or_b32 v24, v113, 16, v112
    v_lshl_or_b32 v25, v115, 16, v114
    v_lshl_or_b32 v26, v117, 16, v116
    v_lshl_or_b32 v27, v119, 16, v118
    buffer_store_dwordx4 v[24:27], v31, s[8:11], s7 offen sc1
    s_add_u32 s7, s7, 1024
    s_waitcnt vmcnt(27)
    v_lshl_or_b32 v24, v121, 16, v120
    v_lshl_or_b32 v25, v123, 16, v122
    v_lshl_or_b32 v26, v125, 16, v124
    v_lshl_or_b32 v27, v127, 16, v126
    buffer_store_dwordx4 v[24:27], v31, s[8:11], s7 offen sc1
    s_add_u32 s7, s7, 1024
    s_waitcnt vmcnt(20)
    v_lshl_or_b32 v24, v129, 16, v128
    v_lshl_or_b32 v25, v131, 16, v130
    v_lshl_or_b32 v26, v133, 16, v132
    v_lshl_or_b32 v27, v135, 16, v134
    buffer_store_dwordx4 v[24:27], v31, s[8:11], s7 offen sc1
    s_add_u32 s7, s7, 1024
    s_waitcnt vmcnt(13)
    v_lshl_or_b32 v24, v137, 16, v136
    v_lshl_or_b32 v25, v139, 16, v138
    v_lshl_or_b32 v26, v141, 16, v140
    v_lshl_or_b32 v27, v143, 16, v142
    buffer_store_dwordx4 v[24:27], v31, s[8:11], s7 offen sc1
    s_add_u32 s7, s7, 1024
    s_waitcnt vmcnt(6)
    v_lshl_or_b32 v24, v145, 16, v144
    v_lshl_or_b32 v25, v147, 16, v146
    v_lshl_or_b32 v26, v149, 16, v148
    v_lshl_or_b32 v27, v151, 16, v150
    buffer_store_dwordx4 v[24:27], v31, s[8:11], s7 offen sc1
    s_add_u32 s7, s7, 1024
    v_mov_b32 v61, 0
    buffer_load_dword v60, v61, s[84:87], 0 offen sc1
    s_waitcnt vmcnt(0)
    s_barrier
    s_cmp_lg_u32 s65, 0
    s_cbranch_scc1 A_ps
    v_readfirstlane_b32 s66, v60
    s_cmp_lg_u32 s66, 0
    s_cbranch_scc1 A_ps_ic_done
    v_mov_b32 v4, 0
    s_mov_b32 s46, 0
A_ps_ic:
    buffer_load_dword v5, v4, s[84:87], 0 offen sc1
    s_waitcnt vmcnt(0)
    v_readfirstlane_b32 s45, v5
    s_cmp_lg_u32 s45, 0
    s_cbranch_scc1 A_ps_ic_ok
    s_add_u32 s46, s46, 1
    s_cmp_ge_u32 s46, 0x20000
    s_cbranch_scc1 A_ps_ic_ok
    s_sleep 2
    s_branch A_ps_ic
A_ps_ic_ok:
    s_mov_b32 s66, 1
A_ps_ic_done:
    s_lshl_b32 s20, s64, 7
    s_add_u32 s20, s20, 25100288
    v_mov_b32 v1, s20
    v_mov_b32 v2, 1
    s_mov_b64 exec, 1
    buffer_atomic_add v2, v1, s[8:11], 0 offen
    s_mov_b64 exec, -1
A_ps:
F_entry:
    s_setprio 0
    s_load_dwordx2 s[36:37], s[0:1], 0
    s_load_dwordx8 s[52:59], s[0:1], 64
    s_load_dwordx4 s[60:63], s[0:1], 96
    s_load_dwordx2 s[64:65], s[0:1], 112
    s_and_b32 s4, s2, 7
    s_lshl_b32 s4, s4, 2
    s_bfe_u32 s5, s2, 0x20003
    s_add_u32 s4, s4, s5
    s_lshr_b32 s5, s2, 5
    v_lshrrev_b32 v1, 6, v0
    v_and_b32 v2, 63, v0
    v_lshlrev_b32 v3, 4, v2
    v_readfirstlane_b32 s28, v1
    s_waitcnt lgkmcnt(0)
    s_mov_b32 s8, s64
    s_and_b32 s9, s65, 0xffff
    s_mov_b32 s10, 25165824
    s_mov_b32 s11, 0x00020000
    s_mul_i32 s6, s4, 224
    s_mul_i32 s7, s28, 28
    s_add_u32 s6, s6, s7
    s_lshl_b32 s6, s6, 10
    s_add_u32 s40, s6, 12582912
    s_add_u32 s41, s40, 114688
    s_mul_i32 s6, s5, 224
    s_add_u32 s6, s6, s7
    s_lshl_b32 s6, s6, 10
    s_add_u32 s42, s6, 8912896
    s_add_u32 s43, s42, 114688
    s_cmp_lg_u32 s28, 0
    s_cbranch_scc1 F_w2ok
    s_cmp_lg_u32 s66, 0
    s_cbranch_scc1 F_ic_done
    v_mov_b32 v4, 0
    s_mov_b32 s46, 0
F_ic:
    buffer_load_dword v5, v4, s[84:87], 0 offen sc1
    s_waitcnt vmcnt(0)
    v_readfirstlane_b32 s45, v5
    s_cmp_lg_u32 s45, 0
    s_cbranch_scc1 F_ic_ok
    s_add_u32 s46, s46, 1
    s_cmp_ge_u32 s46, 0x20000
    s_cbranch_scc1 F_ic_ok
    s_sleep 2
    s_branch F_ic
F_ic_ok:
    s_mov_b32 s66, 1
F_ic_done:
    s_lshr_b32 s6, s5, 1
    s_add_u32 s6, s6, 54
    s_lshl_b32 s44, s6, 7
    s_add_u32 s44, s44, 25100288
    v_mov_b32 v4, s44
    s_mov_b32 s46, 0
F_pw:
    buffer_load_dword v5, v4, s[8:11], 0 offen sc1
    s_waitcnt vmcnt(0)
    v_readfirstlane_b32 s45, v5
    s_cmp_ge_u32 s45, 8
    s_cbranch_scc1 F_pw_ok
    s_add_u32 s46, s46, 1
    s_cmp_ge_u32 s46, 0x20000
    s_cbranch_scc1 F_pw_ok
    s_sleep 4
    s_branch F_pw
F_pw_ok:
F_w2ok:
    s_barrier
    buffer_load_dwordx4 v[104:107], v3, s[8:11], s42 offen offset:0
    buffer_load_dwordx4 v[108:111], v3, s[8:11], s43 offen offset:0
    buffer_load_dwordx4 v[120:123], v3, s[8:11], s42 offen offset:1024
    buffer_load_dwordx4 v[124:127], v3, s[8:11], s43 offen offset:1024
    buffer_load_dwordx4 v[136:139], v3, s[8:11], s42 offen offset:2048
    buffer_load_dwordx4 v[140:143], v3, s[8:11], s43 offen offset:2048
    buffer_load_dwordx4 v[152:155], v3, s[8:11], s42 offen offset:3072
    buffer_load_dwordx4 v[156:159], v3, s[8:11], s43 offen offset:3072
    s_add_u32 s42, s42, 4096
    s_add_u32 s43, s43, 4096
    buffer_load_dwordx4 v[168:171], v3, s[8:11], s42 offen offset:0
    buffer_load_dwordx4 v[172:175], v3, s[8:11], s43 offen offset:0
    buffer_load_dwordx4 v[184:187], v3, s[8:11], s42 offen offset:1024
    buffer_load_dwordx4 v[188:191], v3, s[8:11], s43 offen offset:1024
    buffer_load_dwordx4 v[200:203], v3, s[8:11], s42 offen offset:2048
    buffer_load_dwordx4 v[204:207], v3, s[8:11], s43 offen offset:2048
    buffer_load_dwordx4 v[216:219], v3, s[8:11], s42 offen offset:3072
    buffer_load_dwordx4 v[220:223], v3, s[8:11], s43 offen offset:3072
    s_add_u32 s42, s42, 4096
    s_add_u32 s43, s43, 4096
    buffer_load_dwordx4 v[232:235], v3, s[8:11], s42 offen offset:0
    buffer_load_dwordx4 v[236:239], v3, s[8:11], s43 offen offset:0
    s_lshl_b32 s29, s28, 14
    s_sub_u32 s46, s42, 8192
    s_sub_u32 s47, s43, 8192
    s_add_u32 m0, s29, 0
    s_add_u32 s44, s46, 9216
    buffer_load_dwordx4 v3, s[8:11], s44 offen lds
    s_add_u32 m0, s29, 1024
    s_add_u32 s44, s47, 9216
    buffer_load_dwordx4 v3, s[8:11], s44 offen lds
    s_add_u32 m0, s29, 2048
    s_add_u32 s44, s46, 10240
    buffer_load_dwordx4 v3, s[8:11], s44 offen lds
    s_add_u32 m0, s29, 3072
    s_add_u32 s44, s47, 10240
    buffer_load_dwordx4 v3, s[8:11], s44 offen lds
    s_add_u32 m0, s29, 4096
    s_add_u32 s44, s46, 11264
    buffer_load_dwordx4 v3, s[8:11], s44 offen lds
    s_add_u32 m0, s29, 5120
    s_add_u32 s44, s47, 11264
    buffer_load_dwordx4 v3, s[8:11], s44 offen lds
    s_add_u32 m0, s29, 6144
    s_add_u32 s44, s46, 12288
    buffer_load_dwordx4 v3, s[8:11], s44 offen lds
    s_add_u32 m0, s29, 7168
    s_add_u32 s44, s47, 12288
    buffer_load_dwordx4 v3, s[8:11], s44 offen lds
    s_add_u32 m0, s29, 8192
    s_add_u32 s44, s46, 13312
    buffer_load_dwordx4 v3, s[8:11], s44 offen lds
    s_add_u32 m0, s29, 9216
    s_add_u32 s44, s47, 13312
    buffer_load_dwordx4 v3, s[8:11], s44 offen lds
    s_add_u32 m0, s29, 10240
    s_add_u32 s44, s46, 14336
    buffer_load_dwordx4 v3, s[8:11], s44 offen lds
    s_add_u32 m0, s29, 11264
    s_add_u32 s44, s47, 14336
    buffer_load_dwordx4 v3, s[8:11], s44 offen lds
    s_add_u32 m0, s29, 12288
    s_add_u32 s44, s46, 15360
    buffer_load_dwordx4 v3, s[8:11], s44 offen lds
    s_add_u32 m0, s29, 13312
    s_add_u32 s44, s47, 15360
    buffer_load_dwordx4 v3, s[8:11], s44 offen lds
    s_add_u32 m0, s29, 14336
    s_add_u32 s44, s46, 16384
    buffer_load_dwordx4 v3, s[8:11], s44 offen lds
    s_add_u32 m0, s29, 15360
    s_add_u32 s44, s47, 16384
    buffer_load_dwordx4 v3, s[8:11], s44 offen lds
    v_add_u32 v28, s29, v3
    s_cmp_lg_u32 s28, 0
    s_cbranch_scc1 F_hok
    s_lshr_b32 s6, s4, 1
    s_lshl_b32 s44, s6, 7
    s_add_u32 s44, s44, 25100288
    v_mov_b32 v4, s44
    s_mov_b32 s46, 0
F_ph:
    buffer_load_dword v5, v4, s[8:11], 0 offen sc1
    s_waitcnt vmcnt(0)
    v_readfirstlane_b32 s45, v5
    s_cmp_ge_u32 s45, 14
    s_cbranch_scc1 F_ph_ok
    s_add_u32 s46, s46, 1
    s_cmp_ge_u32 s46, 0x20000
    s_cbranch_scc1 F_ph_ok
    s_sleep 4
    s_branch F_ph
F_ph_ok:
F_hok:
    s_barrier
    buffer_load_dwordx4 v[96:99], v3, s[8:11], s40 offen offset:0 sc1
    buffer_load_dwordx4 v[100:103], v3, s[8:11], s41 offen offset:0 sc1
    buffer_load_dwordx4 v[112:115], v3, s[8:11], s40 offen offset:1024 sc1
    buffer_load_dwordx4 v[116:119], v3, s[8:11], s41 offen offset:1024 sc1
    buffer_load_dwordx4 v[128:131], v3, s[8:11], s40 offen offset:2048 sc1
    buffer_load_dwordx4 v[132:135], v3, s[8:11], s41 offen offset:2048 sc1
    buffer_load_dwordx4 v[144:147], v3, s[8:11], s40 offen offset:3072 sc1
    buffer_load_dwordx4 v[148:151], v3, s[8:11], s41 offen offset:3072 sc1
    s_add_u32 s40, s40, 4096
    s_add_u32 s41, s41, 4096
    buffer_load_dwordx4 v[160:163], v3, s[8:11], s40 offen offset:0 sc1
    buffer_load_dwordx4 v[164:167], v3, s[8:11], s41 offen offset:0 sc1
    buffer_load_dwordx4 v[176:179], v3, s[8:11], s40 offen offset:1024 sc1
    buffer_load_dwordx4 v[180:183], v3, s[8:11], s41 offen offset:1024 sc1
    buffer_load_dwordx4 v[192:195], v3, s[8:11], s40 offen offset:2048 sc1
    buffer_load_dwordx4 v[196:199], v3, s[8:11], s41 offen offset:2048 sc1
    buffer_load_dwordx4 v[208:211], v3, s[8:11], s40 offen offset:3072 sc1
    buffer_load_dwordx4 v[212:215], v3, s[8:11], s41 offen offset:3072 sc1
    s_add_u32 s40, s40, 4096
    s_add_u32 s41, s41, 4096
    buffer_load_dwordx4 v[224:227], v3, s[8:11], s40 offen offset:0 sc1
    buffer_load_dwordx4 v[228:231], v3, s[8:11], s41 offen offset:0 sc1
    s_mov_b32 s12, s56
    s_and_b32 s13, s57, 0xffff
    s_mov_b32 s14, 1835008
    s_mov_b32 s15, 0x00020000
    s_mov_b32 s16, s58
    s_and_b32 s17, s59, 0xffff
    s_mov_b32 s18, 1024
    s_mov_b32 s19, 0x00020000
    s_mov_b32 s20, s36
    s_and_b32 s21, s37, 0xffff
    s_mov_b32 s22, 2097152
    s_mov_b32 s23, 0x00020000
    s_mov_b32 s24, s60
    s_and_b32 s25, s61, 0xffff
    s_mov_b32 s26, 2097152
    s_mov_b32 s27, 0x00020000
    s_mov_b32 s84, s62
    s_and_b32 s85, s63, 0xffff
    s_mov_b32 s86, 256
    s_mov_b32 s87, 0x00020000
    v_and_b32 v9, 31, v2
    v_bfe_u32 v10, v2, 5, 1
    v_lshrrev_b32 v7, 1, v1
    v_and_b32 v8, 1, v1
    v_lshl_add_u32 v17, v7, 5, v9
    s_lshl_b32 s6, s4, 6
    s_lshl_b32 s7, s5, 7
    v_add_u32 v17, s6, v17
    v_lshlrev_b32 v16, 6, v8
    v_lshl_add_u32 v16, v10, 3, v16
    v_add_u32 v16, s7, v16
    v_lshl_add_u32 v18, v17, 10, v16
    v_lshrrev_b32 v4, 3, v0
    v_and_b32 v5, 7, v0
    v_lshlrev_b32 v6, 12, v4
    v_lshl_add_u32 v6, v5, 4, v6
    s_lshl_b32 s30, s5, 18
    s_lshl_b32 s31, s4, 7
    s_add_u32 s30, s30, s31
    s_add_u32 s30, s30, 4194304
    s_add_u32 s31, s30, 131072
    v_mul_u32_u24 v19, 192, v4
    v_lshl_add_u32 v19, v5, 4, v19
    v_add_u32 v19, 65536, v19
    v_mov_b32 v32, 0
    v_mov_b32 v33, 0
    v_mov_b32 v34, 0
    v_mov_b32 v35, 0
    v_mov_b32 v36, 0
    v_mov_b32 v37, 0
    v_mov_b32 v38, 0
    v_mov_b32 v39, 0
    v_mov_b32 v40, 0
    v_mov_b32 v41, 0
    v_mov_b32 v42, 0
    v_mov_b32 v43, 0
    v_mov_b32 v44, 0
    v_mov_b32 v45, 0
    v_mov_b32 v46, 0
    v_mov_b32 v47, 0
    v_mov_b32 v48, 0
    v_mov_b32 v49, 0
    v_mov_b32 v50, 0
    v_mov_b32 v51, 0
    v_mov_b32 v52, 0
    v_mov_b32 v53, 0
    v_mov_b32 v54, 0
    v_mov_b32 v55, 0
    v_mov_b32 v56, 0
    v_mov_b32 v57, 0
    v_mov_b32 v58, 0
    v_mov_b32 v59, 0
    v_mov_b32 v60, 0
    v_mov_b32 v61, 0
    v_mov_b32 v62, 0
    v_mov_b32 v63, 0
    v_mov_b32 v64, 0
    v_mov_b32 v65, 0
    v_mov_b32 v66, 0
    v_mov_b32 v67, 0
    v_mov_b32 v68, 0
    v_mov_b32 v69, 0
    v_mov_b32 v70, 0
    v_mov_b32 v71, 0
    v_mov_b32 v72, 0
    v_mov_b32 v73, 0
    v_mov_b32 v74, 0
    v_mov_b32 v75, 0
    v_mov_b32 v76, 0
    v_mov_b32 v77, 0
    v_mov_b32 v78, 0
    v_mov_b32 v79, 0
    v_mov_b32 v80, 0
    v_mov_b32 v81, 0
    v_mov_b32 v82, 0
    v_mov_b32 v83, 0
    v_mov_b32 v84, 0
    v_mov_b32 v85, 0
    v_mov_b32 v86, 0
    v_mov_b32 v87, 0
    v_mov_b32 v88, 0
    v_mov_b32 v89, 0
    v_mov_b32 v90, 0
    v_mov_b32 v91, 0
    v_mov_b32 v92, 0
    v_mov_b32 v93, 0
    v_mov_b32 v94, 0
    v_mov_b32 v95, 0
    s_add_u32 s47, s5, 16
    s_lshl_b32 s47, s47, 7
    s_add_u32 s47, s47, 25100288
    v_mov_b32 v4, s47
    s_waitcnt vmcnt(16)
    v_mfma_f32_32x32x16_bf16 v[32:47], v[104:107], v[96:99], v[32:47]
    v_mfma_f32_32x32x16_bf16 v[48:63], v[108:111], v[96:99], v[48:63]
    v_mfma_f32_32x32x16_bf16 v[64:79], v[104:107], v[100:103], v[64:79]
    v_mfma_f32_32x32x16_bf16 v[80:95], v[108:111], v[100:103], v[80:95]
    buffer_load_dwordx4 v[96:99], v3, s[8:11], s40 offen offset:1024 sc1
    buffer_load_dwordx4 v[100:103], v3, s[8:11], s41 offen offset:1024 sc1
    s_waitcnt vmcnt(20)
    ds_read_b128 v[104:107], v28 offset:0
    ds_read_b128 v[108:111], v28 offset:1024
    s_waitcnt vmcnt(16)
    v_mfma_f32_32x32x16_bf16 v[32:47], v[120:123], v[112:115], v[32:47]
    v_mfma_f32_32x32x16_bf16 v[48:63], v[124:127], v[112:115], v[48:63]
    v_mfma_f32_32x32x16_bf16 v[64:79], v[120:123], v[116:119], v[64:79]
    v_mfma_f32_32x32x16_bf16 v[80:95], v[124:127], v[116:119], v[80:95]
    buffer_load_dwordx4 v[112:115], v3, s[8:11], s40 offen offset:2048 sc1
    buffer_load_dwordx4 v[116:119], v3, s[8:11], s41 offen offset:2048 sc1
    ds_read_b128 v[120:123], v28 offset:2048
    ds_read_b128 v[124:127], v28 offset:3072
    s_waitcnt vmcnt(16)
    v_mfma_f32_32x32x16_bf16 v[32:47], v[136:139], v[128:131], v[32:47]
    v_mfma_f32_32x32x16_bf16 v[48:63], v[140:143], v[128:131], v[48:63]
    v_mfma_f32_32x32x16_bf16 v[64:79], v[136:139], v[132:135], v[64:79]
    v_mfma_f32_32x32x16_bf16 v[80:95], v[140:143], v[132:135], v[80:95]
    buffer_load_dwordx4 v[128:131], v3, s[8:11], s40 offen offset:3072 sc1
    buffer_load_dwordx4 v[132:135], v3, s[8:11], s41 offen offset:3072 sc1
    ds_read_b128 v[136:139], v28 offset:4096
    ds_read_b128 v[140:143], v28 offset:5120
    s_waitcnt vmcnt(16)
    v_mfma_f32_32x32x16_bf16 v[32:47], v[152:155], v[144:147], v[32:47]
    v_mfma_f32_32x32x16_bf16 v[48:63], v[156:159], v[144:147], v[48:63]
    v_mfma_f32_32x32x16_bf16 v[64:79], v[152:155], v[148:151], v[64:79]
    v_mfma_f32_32x32x16_bf16 v[80:95], v[156:159], v[148:151], v[80:95]
    s_add_u32 s40, s40, 4096
    s_add_u32 s41, s41, 4096
    buffer_load_dwordx4 v[144:147], v3, s[8:11], s40 offen offset:0 sc1
    buffer_load_dwordx4 v[148:151], v3, s[8:11], s41 offen offset:0 sc1
    s_add_u32 s42, s42, 4096
    s_add_u32 s43, s43, 4096
    ds_read_b128 v[152:155], v28 offset:6144
    ds_read_b128 v[156:159], v28 offset:7168
    s_waitcnt vmcnt(16)
    v_mfma_f32_32x32x16_bf16 v[32:47], v[168:171], v[160:163], v[32:47]
    v_mfma_f32_32x32x16_bf16 v[48:63], v[172:175], v[160:163], v[48:63]
    v_mfma_f32_32x32x16_bf16 v[64:79], v[168:171], v[164:167], v[64:79]
    v_mfma_f32_32x32x16_bf16 v[80:95], v[172:175], v[164:167], v[80:95]
    buffer_load_dwordx4 v[160:163], v3, s[8:11], s40 offen offset:1024 sc1
    buffer_load_dwordx4 v[164:167], v3, s[8:11], s41 offen offset:1024 sc1
    ds_read_b128 v[168:171], v28 offset:8192
    ds_read_b128 v[172:175], v28 offset:9216
    s_waitcnt vmcnt(16)
    v_mfma_f32_32x32x16_bf16 v[32:47], v[184:187], v[176:179], v[32:47]
    v_mfma_f32_32x32x16_bf16 v[48:63], v[188:191], v[176:179], v[48:63]
    v_mfma_f32_32x32x16_bf16 v[64:79], v[184:187], v[180:183], v[64:79]
    v_mfma_f32_32x32x16_bf16 v[80:95], v[188:191], v[180:183], v[80:95]
    buffer_load_dwordx4 v[176:179], v3, s[8:11], s40 offen offset:2048 sc1
    buffer_load_dwordx4 v[180:183], v3, s[8:11], s41 offen offset:2048 sc1
    ds_read_b128 v[184:187], v28 offset:10240
    ds_read_b128 v[188:191], v28 offset:11264
    s_waitcnt vmcnt(16)
    v_mfma_f32_32x32x16_bf16 v[32:47], v[200:203], v[192:195], v[32:47]
    v_mfma_f32_32x32x16_bf16 v[48:63], v[204:207], v[192:195], v[48:63]
    v_mfma_f32_32x32x16_bf16 v[64:79], v[200:203], v[196:199], v[64:79]
    v_mfma_f32_32x32x16_bf16 v[80:95], v[204:207], v[196:199], v[80:95]
    buffer_load_dwordx4 v[192:195], v3, s[8:11], s40 offen offset:3072 sc1
    buffer_load_dwordx4 v[196:199], v3, s[8:11], s41 offen offset:3072 sc1
    ds_read_b128 v[200:203], v28 offset:12288
    ds_read_b128 v[204:207], v28 offset:13312
    s_waitcnt vmcnt(16)
    v_mfma_f32_32x32x16_bf16 v[32:47], v[216:219], v[208:211], v[32:47]
    v_mfma_f32_32x32x16_bf16 v[48:63], v[220:223], v[208:211], v[48:63]
    v_mfma_f32_32x32x16_bf16 v[64:79], v[216:219], v[212:215], v[64:79]
    v_mfma_f32_32x32x16_bf16 v[80:95], v[220:223], v[212:215], v[80:95]
    s_add_u32 s40, s40, 4096
    s_add_u32 s41, s41, 4096
    buffer_load_dwordx4 v[208:211], v3, s[8:11], s40 offen offset:0 sc1
    buffer_load_dwordx4 v[212:215], v3, s[8:11], s41 offen offset:0 sc1
    s_add_u32 s42, s42, 4096
    s_add_u32 s43, s43, 4096
    ds_read_b128 v[216:219], v28 offset:14336
    ds_read_b128 v[220:223], v28 offset:15360
    s_waitcnt vmcnt(16)
    v_mfma_f32_32x32x16_bf16 v[32:47], v[232:235], v[224:227], v[32:47]
    v_mfma_f32_32x32x16_bf16 v[48:63], v[236:239], v[224:227], v[48:63]
    v_mfma_f32_32x32x16_bf16 v[64:79], v[232:235], v[228:231], v[64:79]
    v_mfma_f32_32x32x16_bf16 v[80:95], v[236:239], v[228:231], v[80:95]
    buffer_load_dwordx4 v[224:227], v3, s[8:11], s40 offen offset:1024 sc1
    buffer_load_dwordx4 v[228:231], v3, s[8:11], s41 offen offset:1024 sc1
    buffer_load_dwordx4 v[232:235], v3, s[8:11], s42 offen offset:1024
    buffer_load_dwordx4 v[236:239], v3, s[8:11], s43 offen offset:1024
    s_waitcnt lgkmcnt(0)
    s_waitcnt vmcnt(18)
    v_mfma_f32_32x32x16_bf16 v[32:47], v[104:107], v[96:99], v[32:47]
    v_mfma_f32_32x32x16_bf16 v[48:63], v[108:111], v[96:99], v[48:63]
    v_mfma_f32_32x32x16_bf16 v[64:79], v[104:107], v[100:103], v[64:79]
    v_mfma_f32_32x32x16_bf16 v[80:95], v[108:111], v[100:103], v[80:95]
    buffer_load_dwordx4 v[96:99], v3, s[8:11], s40 offen offset:2048 sc1
    buffer_load_dwordx4 v[100:103], v3, s[8:11], s41 offen offset:2048 sc1
    buffer_load_dwordx4 v[104:107], v3, s[8:11], s42 offen offset:2048
    buffer_load_dwordx4 v[108:111], v3, s[8:11], s43 offen offset:2048
    s_waitcnt lgkmcnt(0)
    s_waitcnt vmcnt(20)
    v_mfma_f32_32x32x16_bf16 v[32:47], v[120:123], v[112:115], v[32:47]
    v_mfma_f32_32x32x16_bf16 v[48:63], v[124:127], v[112:115], v[48:63]
    v_mfma_f32_32x32x16_bf16 v[64:79], v[120:123], v[116:119], v[64:79]
    v_mfma_f32_32x32x16_bf16 v[80:95], v[124:127], v[116:119], v[80:95]
    buffer_load_dwordx4 v[112:115], v3, s[8:11], s40 offen offset:3072 sc1
    buffer_load_dwordx4 v[116:119], v3, s[8:11], s41 offen offset:3072 sc1
    buffer_load_dwordx4 v[120:123], v3, s[8:11], s42 offen offset:3072
    buffer_load_dwordx4 v[124:127], v3, s[8:11], s43 offen offset:3072
    s_waitcnt lgkmcnt(0)
    s_waitcnt vmcnt(22)
    v_mfma_f32_32x32x16_bf16 v[32:47], v[136:139], v[128:131], v[32:47]
    v_mfma_f32_32x32x16_bf16 v[48:63], v[140:143], v[128:131], v[48:63]
    v_mfma_f32_32x32x16_bf16 v[64:79], v[136:139], v[132:135], v[64:79]
    v_mfma_f32_32x32x16_bf16 v[80:95], v[140:143], v[132:135], v[80:95]
    s_add_u32 s40, s40, 4096
    s_add_u32 s41, s41, 4096
    s_add_u32 s42, s42, 4096
    s_add_u32 s43, s43, 4096
    buffer_load_dwordx4 v[128:131], v3, s[8:11], s40 offen offset:0 sc1
    buffer_load_dwordx4 v[132:135], v3, s[8:11], s41 offen offset:0 sc1
    buffer_load_dwordx4 v[136:139], v3, s[8:11], s42 offen offset:0
    buffer_load_dwordx4 v[140:143], v3, s[8:11], s43 offen offset:0
    s_waitcnt lgkmcnt(0)
    s_waitcnt vmcnt(24)
    v_mfma_f32_32x32x16_bf16 v[32:47], v[152:155], v[144:147], v[32:47]
    v_mfma_f32_32x32x16_bf16 v[48:63], v[156:159], v[144:147], v[48:63]
    v_mfma_f32_32x32x16_bf16 v[64:79], v[152:155], v[148:151], v[64:79]
    v_mfma_f32_32x32x16_bf16 v[80:95], v[156:159], v[148:151], v[80:95]
    buffer_load_dwordx4 v[144:147], v3, s[8:11], s40 offen offset:1024 sc1
    buffer_load_dwordx4 v[148:151], v3, s[8:11], s41 offen offset:1024 sc1
    buffer_load_dwordx4 v[152:155], v3, s[8:11], s42 offen offset:1024
    buffer_load_dwordx4 v[156:159], v3, s[8:11], s43 offen offset:1024
    s_waitcnt lgkmcnt(0)
    s_waitcnt vmcnt(26)
    v_mfma_f32_32x32x16_bf16 v[32:47], v[168:171], v[160:163], v[32:47]
    v_mfma_f32_32x32x16_bf16 v[48:63], v[172:175], v[160:163], v[48:63]
    v_mfma_f32_32x32x16_bf16 v[64:79], v[168:171], v[164:167], v[64:79]
    v_mfma_f32_32x32x16_bf16 v[80:95], v[172:175], v[164:167], v[80:95]
    buffer_load_dwordx4 v[160:163], v3, s[8:11], s40 offen offset:2048 sc1
    buffer_load_dwordx4 v[164:167], v3, s[8:11], s41 offen offset:2048 sc1
    buffer_load_dwordx4 v[168:171], v3, s[8:11], s42 offen offset:2048
    buffer_load_dwordx4 v[172:175], v3, s[8:11], s43 offen offset:2048
    s_waitcnt lgkmcnt(0)
    buffer_load_dword v5, v4, s[8:11], 0 offen sc1
    s_waitcnt vmcnt(29)
    v_mfma_f32_32x32x16_bf16 v[32:47], v[184:187], v[176:179], v[32:47]
    v_mfma_f32_32x32x16_bf16 v[48:63], v[188:191], v[176:179], v[48:63]
    v_mfma_f32_32x32x16_bf16 v[64:79], v[184:187], v[180:183], v[64:79]
    v_mfma_f32_32x32x16_bf16 v[80:95], v[188:191], v[180:183], v[80:95]
    buffer_load_dwordx4 v[176:179], v3, s[8:11], s40 offen offset:3072 sc1
    buffer_load_dwordx4 v[180:183], v3, s[8:11], s41 offen offset:3072 sc1
    buffer_load_dwordx4 v[184:187], v3, s[8:11], s42 offen offset:3072
    buffer_load_dwordx4 v[188:191], v3, s[8:11], s43 offen offset:3072
    s_waitcnt lgkmcnt(0)
    s_waitcnt vmcnt(31)
    v_mfma_f32_32x32x16_bf16 v[32:47], v[200:203], v[192:195], v[32:47]
    v_mfma_f32_32x32x16_bf16 v[48:63], v[204:207], v[192:195], v[48:63]
    v_mfma_f32_32x32x16_bf16 v[64:79], v[200:203], v[196:199], v[64:79]
    v_mfma_f32_32x32x16_bf16 v[80:95], v[204:207], v[196:199], v[80:95]
    s_add_u32 s40, s40, 4096
    s_add_u32 s41, s41, 4096
    s_add_u32 s42, s42, 4096
    s_add_u32 s43, s43, 4096
    buffer_load_dwordx4 v[192:195], v3, s[8:11], s40 offen offset:0 sc1
    buffer_load_dwordx4 v[196:199], v3, s[8:11], s41 offen offset:0 sc1
    buffer_load_dwordx4 v[200:203], v3, s[8:11], s42 offen offset:0
    buffer_load_dwordx4 v[204:207], v3, s[8:11], s43 offen offset:0
    s_waitcnt lgkmcnt(0)
    s_waitcnt vmcnt(33)
    v_mfma_f32_32x32x16_bf16 v[32:47], v[216:219], v[208:211], v[32:47]
    v_mfma_f32_32x32x16_bf16 v[48:63], v[220:223], v[208:211], v[48:63]
    v_mfma_f32_32x32x16_bf16 v[64:79], v[216:219], v[212:215], v[64:79]
    v_mfma_f32_32x32x16_bf16 v[80:95], v[220:223], v[212:215], v[80:95]
    buffer_load_dwordx4 v[208:211], v3, s[8:11], s40 offen offset:1024 sc1
    buffer_load_dwordx4 v[212:215], v3, s[8:11], s41 offen offset:1024 sc1
    buffer_load_dwordx4 v[216:219], v3, s[8:11], s42 offen offset:1024
    buffer_load_dwordx4 v[220:223], v3, s[8:11], s43 offen offset:1024
    s_waitcnt vmcnt(33)
    v_mfma_f32_32x32x16_bf16 v[32:47], v[232:235], v[224:227], v[32:47]
    v_mfma_f32_32x32x16_bf16 v[48:63], v[236:239], v[224:227], v[48:63]
    v_mfma_f32_32x32x16_bf16 v[64:79], v[232:235], v[228:231], v[64:79]
    v_mfma_f32_32x32x16_bf16 v[80:95], v[236:239], v[228:231], v[80:95]
    buffer_load_dwordx4 v[224:227], v3, s[8:11], s40 offen offset:2048 sc1
    buffer_load_dwordx4 v[228:231], v3, s[8:11], s41 offen offset:2048 sc1
    buffer_load_dwordx4 v[232:235], v3, s[8:11], s42 offen offset:2048
    buffer_load_dwordx4 v[236:239], v3, s[8:11], s43 offen offset:2048
    s_waitcnt vmcnt(33)
    v_mfma_f32_32x32x16_bf16 v[32:47], v[104:107], v[96:99], v[32:47]
    v_mfma_f32_32x32x16_bf16 v[48:63], v[108:111], v[96:99], v[48:63]
    v_mfma_f32_32x32x16_bf16 v[64:79], v[104:107], v[100:103], v[64:79]
    v_mfma_f32_32x32x16_bf16 v[80:95], v[108:111], v[100:103], v[80:95]
    buffer_load_dwordx4 v[96:99], v3, s[8:11], s40 offen offset:3072 sc1
    buffer_load_dwordx4 v[100:103], v3, s[8:11], s41 offen offset:3072 sc1
    buffer_load_dwordx4 v[104:107], v3, s[8:11], s42 offen offset:3072
    buffer_load_dwordx4 v[108:111], v3, s[8:11], s43 offen offset:3072
    s_waitcnt vmcnt(20)
    v_readfirstlane_b32 s45, v5
    s_cmp_ge_u32 s45, 32
    s_cbranch_scc1 F_pa_ok
    s_add_u32 s6, s5, 16
    s_lshl_b32 s44, s6, 7
    s_add_u32 s44, s44, 25100288
    v_mov_b32 v4, s44
    s_mov_b32 s46, 0
F_pa:
    buffer_load_dword v5, v4, s[8:11], 0 offen sc1
    s_waitcnt vmcnt(0)
    v_readfirstlane_b32 s45, v5
    s_cmp_ge_u32 s45, 32
    s_cbranch_scc1 F_pa_ok
    s_add_u32 s46, s46, 1
    s_cmp_ge_u32 s46, 0x20000
    s_cbranch_scc1 F_pa_ok
    s_sleep 4
    s_branch F_pa
F_pa_ok:
    buffer_load_dwordx4 v[240:243], v6, s[8:11], s30 offen sc1
    buffer_load_dwordx4 v[244:247], v6, s[8:11], s31 offen sc1
    buffer_load_dwordx2 v[20:21], v16, s[16:19], 0 offen offset:0
    buffer_load_dwordx2 v[248:249], v18, s[20:23], 0 offen offset:0
    buffer_load_dwordx2 v[22:23], v16, s[16:19], 0 offen offset:16
    buffer_load_dwordx2 v[250:251], v18, s[20:23], 0 offen offset:16
    buffer_load_dwordx2 v[24:25], v16, s[16:19], 0 offen offset:32
    buffer_load_dwordx2 v[252:253], v18, s[20:23], 0 offen offset:32
    buffer_load_dwordx2 v[26:27], v16, s[16:19], 0 offen offset:48
    buffer_load_dwordx2 v[254:255], v18, s[20:23], 0 offen offset:48
    s_waitcnt vmcnt(43)
    v_mfma_f32_32x32x16_bf16 v[32:47], v[120:123], v[112:115], v[32:47]
    v_mfma_f32_32x32x16_bf16 v[48:63], v[124:127], v[112:115], v[48:63]
    v_mfma_f32_32x32x16_bf16 v[64:79], v[120:123], v[116:119], v[64:79]
    v_mfma_f32_32x32x16_bf16 v[80:95], v[124:127], v[116:119], v[80:95]
    s_waitcnt vmcnt(39)
    v_mfma_f32_32x32x16_bf16 v[32:47], v[136:139], v[128:131], v[32:47]
    v_mfma_f32_32x32x16_bf16 v[48:63], v[140:143], v[128:131], v[48:63]
    v_mfma_f32_32x32x16_bf16 v[64:79], v[136:139], v[132:135], v[64:79]
    v_mfma_f32_32x32x16_bf16 v[80:95], v[140:143], v[132:135], v[80:95]
    s_waitcnt vmcnt(35)
    v_mfma_f32_32x32x16_bf16 v[32:47], v[152:155], v[144:147], v[32:47]
    v_mfma_f32_32x32x16_bf16 v[48:63], v[156:159], v[144:147], v[48:63]
    v_mfma_f32_32x32x16_bf16 v[64:79], v[152:155], v[148:151], v[64:79]
    v_mfma_f32_32x32x16_bf16 v[80:95], v[156:159], v[148:151], v[80:95]
    s_waitcnt vmcnt(31)
    v_mfma_f32_32x32x16_bf16 v[32:47], v[168:171], v[160:163], v[32:47]
    v_mfma_f32_32x32x16_bf16 v[48:63], v[172:175], v[160:163], v[48:63]
    v_mfma_f32_32x32x16_bf16 v[64:79], v[168:171], v[164:167], v[64:79]
    v_mfma_f32_32x32x16_bf16 v[80:95], v[172:175], v[164:167], v[80:95]
    s_waitcnt vmcnt(26)
    v_mfma_f32_32x32x16_bf16 v[32:47], v[184:187], v[176:179], v[32:47]
    v_mfma_f32_32x32x16_bf16 v[48:63], v[188:191], v[176:179], v[48:63]
    v_mfma_f32_32x32x16_bf16 v[64:79], v[184:187], v[180:183], v[64:79]
    v_mfma_f32_32x32x16_bf16 v[80:95], v[188:191], v[180:183], v[80:95]
    s_waitcnt vmcnt(22)
    v_mfma_f32_32x32x16_bf16 v[32:47], v[200:203], v[192:195], v[32:47]
    v_mfma_f32_32x32x16_bf16 v[48:63], v[204:207], v[192:195], v[48:63]
    v_mfma_f32_32x32x16_bf16 v[64:79], v[200:203], v[196:199], v[64:79]
    v_mfma_f32_32x32x16_bf16 v[80:95], v[204:207], v[196:199], v[80:95]
    s_waitcnt vmcnt(18)
    v_mfma_f32_32x32x16_bf16 v[32:47], v[216:219], v[208:211], v[32:47]
    v_mfma_f32_32x32x16_bf16 v[48:63], v[220:223], v[208:211], v[48:63]
    v_mfma_f32_32x32x16_bf16 v[64:79], v[216:219], v[212:215], v[64:79]
    v_mfma_f32_32x32x16_bf16 v[80:95], v[220:223], v[212:215], v[80:95]
    s_waitcnt vmcnt(14)
    v_mfma_f32_32x32x16_bf16 v[32:47], v[232:235], v[224:227], v[32:47]
    v_mfma_f32_32x32x16_bf16 v[48:63], v[236:239], v[224:227], v[48:63]
    v_mfma_f32_32x32x16_bf16 v[64:79], v[232:235], v[228:231], v[64:79]
    v_mfma_f32_32x32x16_bf16 v[80:95], v[236:239], v[228:231], v[80:95]
    s_waitcnt vmcnt(10)
    v_mfma_f32_32x32x16_bf16 v[32:47], v[104:107], v[96:99], v[32:47]
    v_mfma_f32_32x32x16_bf16 v[48:63], v[108:111], v[96:99], v[48:63]
    v_mfma_f32_32x32x16_bf16 v[64:79], v[104:107], v[100:103], v[64:79]
    v_mfma_f32_32x32x16_bf16 v[80:95], v[108:111], v[100:103], v[80:95]
    s_nop 7
    s_nop 7
    v_lshlrev_b32 v16, 4, v2
    v_lshl_add_u32 v17, v1, 14, v16
    ds_write_b128 v17, v[32:35] offset:0
    ds_write_b128 v17, v[36:39] offset:1024
    ds_write_b128 v17, v[40:43] offset:2048
    ds_write_b128 v17, v[44:47] offset:3072
    ds_write_b128 v17, v[48:51] offset:4096
    ds_write_b128 v17, v[52:55] offset:5120
    ds_write_b128 v17, v[56:59] offset:6144
    ds_write_b128 v17, v[60:63] offset:7168
    ds_write_b128 v17, v[64:67] offset:8192
    ds_write_b128 v17, v[68:71] offset:9216
    ds_write_b128 v17, v[72:75] offset:10240
    ds_write_b128 v17, v[76:79] offset:11264
    ds_write_b128 v17, v[80:83] offset:12288
    ds_write_b128 v17, v[84:87] offset:13312
    ds_write_b128 v17, v[88:91] offset:14336
    ds_write_b128 v17, v[92:95] offset:15360
    s_waitcnt vmcnt(0)
    ds_write_b128 v19, v[240:243]
    ds_write_b128 v19, v[244:247] offset:6144
    v_bfe_u32 v6, v2, 2, 2
    v_lshl_add_u32 v6, v10, 2, v6
    v_lshl_add_u32 v6, v8, 5, v6
    v_mul_u32_u24 v6, 192, v6
    v_bfe_u32 v4, v2, 4, 1
    v_lshl_add_u32 v6, v4, 5, v6
    v_and_b32 v4, 3, v2
    v_lshl_add_u32 v6, v4, 3, v6
    v_lshl_add_u32 v6, v7, 6, v6
    v_add_u32 v6, 65536, v6
    s_waitcnt lgkmcnt(0)
    s_barrier
    v_lshl_add_u32 v17, v1, 12, v16
    ds_read_b128 v[128:131], v17 offset:0
    ds_read_b128 v[132:135], v17 offset:1024
    ds_read_b128 v[136:139], v17 offset:2048
    ds_read_b128 v[140:143], v17 offset:3072
    ds_read_b128 v[144:147], v17 offset:16384
    ds_read_b128 v[148:151], v17 offset:17408
    ds_read_b128 v[152:155], v17 offset:18432
    ds_read_b128 v[156:159], v17 offset:19456
    ds_read_b128 v[160:163], v17 offset:32768
    ds_read_b128 v[164:167], v17 offset:33792
    ds_read_b128 v[168:171], v17 offset:34816
    ds_read_b128 v[172:175], v17 offset:35840
    ds_read_b128 v[176:179], v17 offset:49152
    ds_read_b128 v[180:183], v17 offset:50176
    ds_read_b128 v[184:187], v17 offset:51200
    ds_read_b128 v[188:191], v17 offset:52224
    ds_read_b64_tr_b16 v[96:97], v6 offset:0
    ds_read_b64_tr_b16 v[98:99], v6 offset:1536
    ds_read_b64_tr_b16 v[100:101], v6 offset:3072
    ds_read_b64_tr_b16 v[102:103], v6 offset:4608
    s_waitcnt lgkmcnt(4)
    v_add_f32 v128, v128, v144
    v_add_f32 v160, v160, v176
    v_add_f32 v64, v128, v160
    v_add_f32 v129, v129, v145
    v_add_f32 v161, v161, v177
    v_add_f32 v65, v129, v161
    v_add_f32 v130, v130, v146
    v_add_f32 v162, v162, v178
    v_add_f32 v66, v130, v162
    v_add_f32 v131, v131, v147
    v_add_f32 v163, v163, v179
    v_add_f32 v67, v131, v163
    v_add_f32 v132, v132, v148
    v_add_f32 v164, v164, v180
    v_add_f32 v68, v132, v164
    v_add_f32 v133, v133, v149
    v_add_f32 v165, v165, v181
    v_add_f32 v69, v133, v165
    v_add_f32 v134, v134, v150
    v_add_f32 v166, v166, v182
    v_add_f32 v70, v134, v166
    v_add_f32 v135, v135, v151
    v_add_f32 v167, v167, v183
    v_add_f32 v71, v135, v167
    v_add_f32 v136, v136, v152
    v_add_f32 v168, v168, v184
    v_add_f32 v72, v136, v168
    v_add_f32 v137, v137, v153
    v_add_f32 v169, v169, v185
    v_add_f32 v73, v137, v169
    v_add_f32 v138, v138, v154
    v_add_f32 v170, v170, v186
    v_add_f32 v74, v138, v170
    v_add_f32 v139, v139, v155
    v_add_f32 v171, v171, v187
    v_add_f32 v75, v139, v171
    v_add_f32 v140, v140, v156
    v_add_f32 v172, v172, v188
    v_add_f32 v76, v140, v172
    v_add_f32 v141, v141, v157
    v_add_f32 v173, v173, v189
    v_add_f32 v77, v141, v173
    v_add_f32 v142, v142, v158
    v_add_f32 v174, v174, v190
    v_add_f32 v78, v142, v174
    v_add_f32 v143, v143, v159
    v_add_f32 v175, v175, v191
    v_add_f32 v79, v143, v175
    s_waitcnt lgkmcnt(0)
    v_cvt_pk_bf16_f32 v110, v64, v65
    v_lshlrev_b32 v111, 16, v110
    v_and_b32 v112, 0xffff0000, v110
    v_lshlrev_b32 v113, 16, v20
    v_and_b32 v114, 0xffff0000, v20
    v_add_f32 v111, v111, v113
    v_add_f32 v112, v112, v114
    v_cvt_pk_bf16_f32 v110, v111, v112
    v_lshlrev_b32 v111, 16, v110
    v_and_b32 v112, 0xffff0000, v110
    v_lshlrev_b32 v113, 16, v248
    v_and_b32 v114, 0xffff0000, v248
    v_lshlrev_b32 v115, 16, v96
    v_and_b32 v116, 0xffff0000, v96
    v_add_f32 v113, v113, v115
    v_add_f32 v114, v114, v116
    v_cvt_pk_bf16_f32 v110, v113, v114
    v_lshlrev_b32 v113, 16, v110
    v_and_b32 v114, 0xffff0000, v110
    v_add_f32 v113, v113, v111
    v_add_f32 v114, v114, v112
    v_cvt_pk_bf16_f32 v120, v113, v114
    v_cvt_pk_bf16_f32 v110, v66, v67
    v_lshlrev_b32 v111, 16, v110
    v_and_b32 v112, 0xffff0000, v110
    v_lshlrev_b32 v113, 16, v21
    v_and_b32 v114, 0xffff0000, v21
    v_add_f32 v111, v111, v113
    v_add_f32 v112, v112, v114
    v_cvt_pk_bf16_f32 v110, v111, v112
    v_lshlrev_b32 v111, 16, v110
    v_and_b32 v112, 0xffff0000, v110
    v_lshlrev_b32 v113, 16, v249
    v_and_b32 v114, 0xffff0000, v249
    v_lshlrev_b32 v115, 16, v97
    v_and_b32 v116, 0xffff0000, v97
    v_add_f32 v113, v113, v115
    v_add_f32 v114, v114, v116
    v_cvt_pk_bf16_f32 v110, v113, v114
    v_lshlrev_b32 v113, 16, v110
    v_and_b32 v114, 0xffff0000, v110
    v_add_f32 v113, v113, v111
    v_add_f32 v114, v114, v112
    v_cvt_pk_bf16_f32 v121, v113, v114
    buffer_store_dwordx2 v[120:121], v18, s[24:27], 0 offen offset:0
    v_cvt_pk_bf16_f32 v110, v68, v69
    v_lshlrev_b32 v111, 16, v110
    v_and_b32 v112, 0xffff0000, v110
    v_lshlrev_b32 v113, 16, v22
    v_and_b32 v114, 0xffff0000, v22
    v_add_f32 v111, v111, v113
    v_add_f32 v112, v112, v114
    v_cvt_pk_bf16_f32 v110, v111, v112
    v_lshlrev_b32 v111, 16, v110
    v_and_b32 v112, 0xffff0000, v110
    v_lshlrev_b32 v113, 16, v250
    v_and_b32 v114, 0xffff0000, v250
    v_lshlrev_b32 v115, 16, v98
    v_and_b32 v116, 0xffff0000, v98
    v_add_f32 v113, v113, v115
    v_add_f32 v114, v114, v116
    v_cvt_pk_bf16_f32 v110, v113, v114
    v_lshlrev_b32 v113, 16, v110
    v_and_b32 v114, 0xffff0000, v110
    v_add_f32 v113, v113, v111
    v_add_f32 v114, v114, v112
    v_cvt_pk_bf16_f32 v122, v113, v114
    v_cvt_pk_bf16_f32 v110, v70, v71
    v_lshlrev_b32 v111, 16, v110
    v_and_b32 v112, 0xffff0000, v110
    v_lshlrev_b32 v113, 16, v23
    v_and_b32 v114, 0xffff0000, v23
    v_add_f32 v111, v111, v113
    v_add_f32 v112, v112, v114
    v_cvt_pk_bf16_f32 v110, v111, v112
    v_lshlrev_b32 v111, 16, v110
    v_and_b32 v112, 0xffff0000, v110
    v_lshlrev_b32 v113, 16, v251
    v_and_b32 v114, 0xffff0000, v251
    v_lshlrev_b32 v115, 16, v99
    v_and_b32 v116, 0xffff0000, v99
    v_add_f32 v113, v113, v115
    v_add_f32 v114, v114, v116
    v_cvt_pk_bf16_f32 v110, v113, v114
    v_lshlrev_b32 v113, 16, v110
    v_and_b32 v114, 0xffff0000, v110
    v_add_f32 v113, v113, v111
    v_add_f32 v114, v114, v112
    v_cvt_pk_bf16_f32 v123, v113, v114
    buffer_store_dwordx2 v[122:123], v18, s[24:27], 0 offen offset:16
    v_cvt_pk_bf16_f32 v110, v72, v73
    v_lshlrev_b32 v111, 16, v110
    v_and_b32 v112, 0xffff0000, v110
    v_lshlrev_b32 v113, 16, v24
    v_and_b32 v114, 0xffff0000, v24
    v_add_f32 v111, v111, v113
    v_add_f32 v112, v112, v114
    v_cvt_pk_bf16_f32 v110, v111, v112
    v_lshlrev_b32 v111, 16, v110
    v_and_b32 v112, 0xffff0000, v110
    v_lshlrev_b32 v113, 16, v252
    v_and_b32 v114, 0xffff0000, v252
    v_lshlrev_b32 v115, 16, v100
    v_and_b32 v116, 0xffff0000, v100
    v_add_f32 v113, v113, v115
    v_add_f32 v114, v114, v116
    v_cvt_pk_bf16_f32 v110, v113, v114
    v_lshlrev_b32 v113, 16, v110
    v_and_b32 v114, 0xffff0000, v110
    v_add_f32 v113, v113, v111
    v_add_f32 v114, v114, v112
    v_cvt_pk_bf16_f32 v120, v113, v114
    v_cvt_pk_bf16_f32 v110, v74, v75
    v_lshlrev_b32 v111, 16, v110
    v_and_b32 v112, 0xffff0000, v110
    v_lshlrev_b32 v113, 16, v25
    v_and_b32 v114, 0xffff0000, v25
    v_add_f32 v111, v111, v113
    v_add_f32 v112, v112, v114
    v_cvt_pk_bf16_f32 v110, v111, v112
    v_lshlrev_b32 v111, 16, v110
    v_and_b32 v112, 0xffff0000, v110
    v_lshlrev_b32 v113, 16, v253
    v_and_b32 v114, 0xffff0000, v253
    v_lshlrev_b32 v115, 16, v101
    v_and_b32 v116, 0xffff0000, v101
    v_add_f32 v113, v113, v115
    v_add_f32 v114, v114, v116
    v_cvt_pk_bf16_f32 v110, v113, v114
    v_lshlrev_b32 v113, 16, v110
    v_and_b32 v114, 0xffff0000, v110
    v_add_f32 v113, v113, v111
    v_add_f32 v114, v114, v112
    v_cvt_pk_bf16_f32 v121, v113, v114
    buffer_store_dwordx2 v[120:121], v18, s[24:27], 0 offen offset:32
    v_cvt_pk_bf16_f32 v110, v76, v77
    v_lshlrev_b32 v111, 16, v110
    v_and_b32 v112, 0xffff0000, v110
    v_lshlrev_b32 v113, 16, v26
    v_and_b32 v114, 0xffff0000, v26
    v_add_f32 v111, v111, v113
    v_add_f32 v112, v112, v114
    v_cvt_pk_bf16_f32 v110, v111, v112
    v_lshlrev_b32 v111, 16, v110
    v_and_b32 v112, 0xffff0000, v110
    v_lshlrev_b32 v113, 16, v254
    v_and_b32 v114, 0xffff0000, v254
    v_lshlrev_b32 v115, 16, v102
    v_and_b32 v116, 0xffff0000, v102
    v_add_f32 v113, v113, v115
    v_add_f32 v114, v114, v116
    v_cvt_pk_bf16_f32 v110, v113, v114
    v_lshlrev_b32 v113, 16, v110
    v_and_b32 v114, 0xffff0000, v110
    v_add_f32 v113, v113, v111
    v_add_f32 v114, v114, v112
    v_cvt_pk_bf16_f32 v122, v113, v114
    v_cvt_pk_bf16_f32 v110, v78, v79
    v_lshlrev_b32 v111, 16, v110
    v_and_b32 v112, 0xffff0000, v110
    v_lshlrev_b32 v113, 16, v27
    v_and_b32 v114, 0xffff0000, v27
    v_add_f32 v111, v111, v113
    v_add_f32 v112, v112, v114
    v_cvt_pk_bf16_f32 v110, v111, v112
    v_lshlrev_b32 v111, 16, v110
    v_and_b32 v112, 0xffff0000, v110
    v_lshlrev_b32 v113, 16, v255
    v_and_b32 v114, 0xffff0000, v255
    v_lshlrev_b32 v115, 16, v103
    v_and_b32 v116, 0xffff0000, v103
    v_add_f32 v113, v113, v115
    v_add_f32 v114, v114, v116
    v_cvt_pk_bf16_f32 v110, v113, v114
    v_lshlrev_b32 v113, 16, v110
    v_and_b32 v114, 0xffff0000, v110
    v_add_f32 v113, v113, v111
    v_add_f32 v114, v114, v112
    v_cvt_pk_bf16_f32 v123, v113, v114
    buffer_store_dwordx2 v[122:123], v18, s[24:27], 0 offen offset:48
F_end:
M_end:
    s_endpgm
.section .rodata,"a"
.p2align 6
.amdhsa_kernel mono_kernel
  .amdhsa_next_free_vgpr 256
  .amdhsa_next_free_sgpr 100
  .amdhsa_accum_offset 256
  .amdhsa_group_segment_fixed_size 0
  .amdhsa_kernarg_size 120
  .amdhsa_user_sgpr_count 2
  .amdhsa_user_sgpr_kernarg_segment_ptr 1
  .amdhsa_system_sgpr_workgroup_id_x 1
.end_amdhsa_kernel
```
